```python
import torch

def _softmax(x, axis=-1):
    return torch.softmax(x, dim=axis)
def _gelu(x):
    return torch.nn.functional.gelu(x, approximate="tanh")
def _silu(x):
    return torch.nn.functional.silu(x)
def _sigmoid(x):
    return torch.sigmoid(x)
def _layernorm(x, axis=-1, eps=1e-5):
    m = x.mean(dim=axis, keepdim=True)
    v = x.var(dim=axis, keepdim=True, unbiased=False)
    return (x - m) / torch.sqrt(v + eps)
def _scatter_add(tgt, idx, src, axis=0):
    return tgt.clone().index_add_(axis, idx, src)
def _segment_sum(src, seg, n):
    out = torch.zeros((n,) + src.shape[1:], dtype=src.dtype)
    return out.index_add_(0, seg, src)
def _pad(x, pw):
    flat = tuple(v for pair in reversed(pw) for v in pair)
    return torch.nn.functional.pad(x, flat)

kernel_name = 'sequential_preLN__mha_block_cached__glu_gated_geglu__decode'

def setup_inputs():

    _w = (lambda a: (lambda t: t.to(torch.bfloat16) if t.is_floating_point() else t)(torch.as_tensor(a)))
    def _A_setup():
        B, Sq, D = 2, 1, 576
        H, Sk, Dh = 32, 8192, 128
        return {
            "x": _w((lambda *s: torch.randn(*s, dtype=torch.bfloat16) * 0.05)(B, Sq, D)),
            "k_cache": _w((lambda *s: torch.randn(*s, dtype=torch.bfloat16) * 1.6)(B, H, Sk, Dh)),
            "v_cache": _w((lambda *s: torch.randn(*s, dtype=torch.bfloat16) * 0.8)(B, H, Sk, Dh)),
            "wq": _w((lambda *s: torch.randn(*s, dtype=torch.bfloat16) * 1.6)(D, H * Dh) * (D ** -0.5)),
            "wo": _w((lambda *s: torch.randn(*s, dtype=torch.bfloat16) * 0.8)(H * Dh, D) * ((H * Dh) ** -0.5)),
        }
    _A_in = _A_setup()

    def _B_setup():
        B, S, Dm, Df = 2, 1, 576, 4608
        return {
            "x": _w((lambda *s: torch.randn(*s, dtype=torch.bfloat16) * 0.05)(B, S, Dm)),
            "w_gate": _w((lambda *s: torch.randn(*s, dtype=torch.bfloat16) * 0.8)(Dm, Df) * (Dm ** -0.5)),
            "w_up": _w((lambda *s: torch.randn(*s, dtype=torch.bfloat16) * 0.8)(Dm, Df) * (Dm ** -0.5)),
            "w_down": _w((lambda *s: torch.randn(*s, dtype=torch.bfloat16) * 0.8)(Df, Dm) * (Df ** -0.5)),
        }
    _B_in = _B_setup()

    return {
        "A_x": _A_in["x"],
        "A_k_cache": _A_in["k_cache"],
        "A_v_cache": _A_in["v_cache"],
        "A_wq": _A_in["wq"],
        "A_wo": _A_in["wo"],
        "B_x": _B_in["x"],
        "B_w_gate": _B_in["w_gate"],
        "B_w_up": _B_in["w_up"],
        "B_w_down": _B_in["w_down"],
    }

def reference(A_x, A_k_cache, A_v_cache, A_wq, A_wo, B_x, B_w_gate, B_w_up, B_w_down):
    def _A_ref(x, k_cache, v_cache, wq, wo):
        B, Sq, D = x.shape
        H, Dh = 32, 128
        q = (lambda x, *d: x.permute(*d))((x @ wq).reshape(B, Sq, H, Dh), 0, 2, 1, 3)
        scores = torch.einsum("bhqd,bhkd->bhqk", q, k_cache) * (Dh ** -0.5)
        p = _softmax(scores, axis=-1)
        o = torch.einsum("bhqk,bhkd->bhqd", p, v_cache)
        return (lambda x, *d: x.permute(*d))(o, 0, 2, 1, 3).reshape(B, Sq, H * Dh) @ wo

    def _B_ref(x, w_gate, w_up, w_down):
        g = torch.einsum("bsd,df->bsf", x, w_gate)
        u = torch.einsum("bsd,df->bsf", x, w_up)
        h = _gelu(g) * u
        return torch.einsum("bsf,fd->bsd", h, w_down)

    x = A_x
    h = x + _A_ref(_layernorm(x, axis=-1), A_k_cache, A_v_cache, A_wq, A_wo)
    h2 = h + _B_ref(_layernorm(h, axis=-1), B_w_gate, B_w_up, B_w_down)
    return h2
```

```asm
; @launch grid=(256,1,1) block=(576,1,1) lds=126976
.amdgcn_target "amdgcn-amd-amdhsa--gfx950"
.text
.globl sequential_preLN__mha_block_cached__glu_gated_geglu__decode_kernel
.p2align 8
.type sequential_preLN__mha_block_cached__glu_gated_geglu__decode_kernel,@function
sequential_preLN__mha_block_cached__glu_gated_geglu__decode_kernel:
  s_cmp_ge_u32 s2, 256
  s_cbranch_scc1 L_end
  s_load_dwordx16 s[4:19], s[0:1], 0
  s_load_dwordx8 s[20:27], s[0:1], 64
  v_lshrrev_b32 v32, 6, v0
  v_and_b32 v1, 63, v0
  s_and_b32 s69, s2, 7
  v_readfirstlane_b32 s64, v32
  s_lshr_b32 s68, s2, 3
  s_lshr_b32 s66, s68, 4
  s_and_b32 s76, s68, 15
  s_lshl_b32 s77, s69, 4
  s_add_u32 s76, s76, s77
  s_lshr_b32 s67, s76, 2
  s_lshl_b32 s65, s66, 7
  s_add_u32 s65, s65, s76
  v_lshlrev_b32 v33, 4, v1
  v_lshl_add_u32 v4, v32, 12, v33
  v_lshrrev_b32 v2, 4, v1
  v_and_b32 v3, 15, v1
  s_cmp_eq_u32 s64, 8
  s_cbranch_scc1 L_help
  s_mul_i32 s70, s65, 5
  s_and_b32 s70, s70, 15
  s_lshl_b32 s70, s70, 15
  s_lshl_b32 s76, s65, 19
  s_mov_b32 s30, 0x80000
  s_mov_b32 s31, 0x20000
  s_waitcnt lgkmcnt(0)
  s_add_u32 s28, s6, s76
  s_addc_u32 s29, s7, 0
  buffer_load_dwordx4 v[44:47], v4, s[28:31], s70 offen offset:0 nt
  buffer_load_dwordx4 v[48:51], v4, s[28:31], s70 offen offset:1024 nt
  buffer_load_dwordx4 v[52:55], v4, s[28:31], s70 offen offset:2048 nt
  s_add_u32 s32, s8, s76
  s_addc_u32 s33, s9, 0
  s_mov_b32 s34, 0x80000
  s_mov_b32 s35, 0x20000
  s_mov_b32 s80, 0x22222222
  s_mov_b32 s81, 0x22222222
  s_mov_b32 s82, 0x44444444
  s_mov_b32 s83, 0x44444444
  s_mov_b32 s84, 0x88888888
  s_mov_b32 s85, 0x88888888
  s_mov_b32 s52, s26
  s_mov_b32 s53, s27
  s_mov_b32 s54, 2097152
  s_mov_b32 s55, 0x20000
  v_and_b32 v37, 1, v1
  v_lshlrev_b32 v37, 4, v37
  v_mov_b32 v39, 0xffff
  v_lshlrev_b32 v37, v37, v39
  v_bfe_u32 v39, v1, 1, 2
  v_cmp_eq_u32 vcc, 0, v39
  s_nop 1
  v_cndmask_b32 v6, 0, v37, vcc
  v_cmp_eq_u32 vcc, 1, v39
  s_nop 1
  v_cndmask_b32 v7, 0, v37, vcc
  v_cmp_eq_u32 vcc, 2, v39
  s_nop 1
  v_cndmask_b32 v8, 0, v37, vcc
  v_cmp_eq_u32 vcc, 3, v39
  s_nop 1
  v_cndmask_b32 v9, 0, v37, vcc
  s_mov_b32 s86, 0x3f803f80
  s_mov_b32 s91, 0x3ae38e39
  v_mov_b32 v5, 0
  s_and_b32 s76, s68, 7
  s_lshl_b32 s76, s76, 3
  s_add_u32 s76, s76, s64
  s_lshl_b32 s76, s76, 10
  v_and_b32 v32, 7, v1
  v_lshl_add_u32 v32, v32, 7, s76
  v_min_u32 v32, L_end-sequential_preLN__mha_block_cached__glu_gated_geglu__decode_kernel-64, v32
  s_getpc_b64 s[76:77]
L_warm:
  s_sub_u32 s76, s76, L_warm-sequential_preLN__mha_block_cached__glu_gated_geglu__decode_kernel
  s_subb_u32 s77, s77, 0
  global_load_dword v32, v32, s[76:77]
  s_barrier
  s_cmp_ge_u32 s64, 4
  s_cbranch_scc1 L_wx0
  s_waitcnt vmcnt(3)
L_wx0:
  buffer_load_dwordx4 v[56:59], v4, s[28:31], s70 offen offset:3072 nt
  s_add_u32 s70, s70, 0x8000
  s_and_b32 s70, s70, 0x7ffff
  s_cmp_ge_u32 s64, 4
  s_cbranch_scc1 L_wx1
  s_waitcnt vmcnt(3)
L_wx1:
  buffer_load_dwordx4 v[60:63], v4, s[28:31], s70 offen offset:0 nt
  s_waitcnt vmcnt(5)
  s_waitcnt vmcnt(4)
  s_waitcnt vmcnt(3)
  buffer_load_dwordx4 v[64:67], v4, s[28:31], s70 offen offset:1024 nt
  s_waitcnt vmcnt(2)
  buffer_load_dwordx4 v[68:71], v4, s[28:31], s70 offen offset:2048 nt
  s_waitcnt vmcnt(2)
  buffer_load_dwordx4 v[72:75], v4, s[28:31], s70 offen offset:3072 nt
  s_add_u32 s70, s70, 0x8000
  s_and_b32 s70, s70, 0x7ffff
  s_waitcnt vmcnt(2)
  buffer_load_dwordx4 v[76:79], v4, s[28:31], s70 offen offset:0 nt
  s_waitcnt vmcnt(2)
  buffer_load_dwordx4 v[80:83], v4, s[28:31], s70 offen offset:1024 nt
  s_waitcnt vmcnt(2)
  buffer_load_dwordx4 v[84:87], v4, s[28:31], s70 offen offset:2048 nt
  s_waitcnt vmcnt(2)
  buffer_load_dwordx4 v[88:91], v4, s[28:31], s70 offen offset:3072 nt
  s_add_u32 s70, s70, 0x8000
  s_and_b32 s70, s70, 0x7ffff
  s_waitcnt vmcnt(2)
  buffer_load_dwordx4 v[92:95], v4, s[28:31], s70 offen offset:0 nt
  s_waitcnt vmcnt(2)
  buffer_load_dwordx4 v[96:99], v4, s[28:31], s70 offen offset:1024 nt
  s_waitcnt vmcnt(2)
  buffer_load_dwordx4 v[100:103], v4, s[28:31], s70 offen offset:2048 nt
  s_waitcnt vmcnt(2)
  buffer_load_dwordx4 v[104:107], v4, s[28:31], s70 offen offset:3072 nt
  s_add_u32 s70, s70, 0x8000
  s_and_b32 s70, s70, 0x7ffff
  s_waitcnt vmcnt(2)
  buffer_load_dwordx4 v[108:111], v4, s[28:31], s70 offen offset:0 nt
  s_waitcnt vmcnt(2)
  buffer_load_dwordx4 v[112:115], v4, s[28:31], s70 offen offset:1024 nt
  s_waitcnt vmcnt(2)
  buffer_load_dwordx4 v[116:119], v4, s[28:31], s70 offen offset:2048 nt
  s_waitcnt vmcnt(2)
  buffer_load_dwordx4 v[120:123], v4, s[28:31], s70 offen offset:3072 nt
  s_add_u32 s70, s70, 0x8000
  s_and_b32 s70, s70, 0x7ffff
  s_waitcnt vmcnt(2)
  buffer_load_dwordx4 v[124:127], v4, s[28:31], s70 offen offset:0 nt
  s_waitcnt vmcnt(2)
  buffer_load_dwordx4 v[128:131], v4, s[28:31], s70 offen offset:1024 nt
  s_waitcnt vmcnt(2)
  buffer_load_dwordx4 v[132:135], v4, s[28:31], s70 offen offset:2048 nt
  s_waitcnt vmcnt(2)
  buffer_load_dwordx4 v[136:139], v4, s[28:31], s70 offen offset:3072 nt
  s_add_u32 s70, s70, 0x8000
  s_and_b32 s70, s70, 0x7ffff
  s_waitcnt vmcnt(2)
  buffer_load_dwordx4 v[140:143], v4, s[28:31], s70 offen offset:0 nt
  s_waitcnt vmcnt(2)
  buffer_load_dwordx4 v[144:147], v4, s[28:31], s70 offen offset:1024 nt
  s_waitcnt vmcnt(2)
  buffer_load_dwordx4 v[148:151], v4, s[28:31], s70 offen offset:2048 nt
  s_waitcnt vmcnt(2)
  buffer_load_dwordx4 v[152:155], v4, s[28:31], s70 offen offset:3072 nt
  s_add_u32 s70, s70, 0x8000
  s_and_b32 s70, s70, 0x7ffff
  v_lshlrev_b32 v35, 4, v3
  s_mov_b32 s87, 0
L_qr:
  ds_read_b128 v[12:15], v35 offset:0
  s_waitcnt lgkmcnt(0)
  v_max3_u32 v36, v12, v13, v14
  v_max_u32 v36, v36, v15
  v_cmp_eq_u32 s[76:77], -1, v36
  s_cmp_eq_u64 s[76:77], 0
  s_nop 2
  s_cbranch_scc1 L_qr_ok
  s_sleep 2
  s_add_u32 s87, s87, 1
  s_cmp_lt_u32 s87, 400000
  s_cbranch_scc1 L_qr
L_qr_ok:
  s_waitcnt vmcnt(2)
  buffer_load_dwordx4 v[156:159], v4, s[28:31], s70 offen offset:0 nt
  v_dot2_f32_bf16 v32, v44, v12, 0
  v_dot2_f32_bf16 v33, v48, v12, 0
  v_dot2_f32_bf16 v34, v52, v12, 0
  v_dot2_f32_bf16 v35, v56, v12, 0
  v_dot2_f32_bf16 v32, v45, v13, v32
  v_dot2_f32_bf16 v33, v49, v13, v33
  v_dot2_f32_bf16 v34, v53, v13, v34
  v_dot2_f32_bf16 v35, v57, v13, v35
  v_dot2_f32_bf16 v32, v46, v14, v32
  v_dot2_f32_bf16 v33, v50, v14, v33
  v_dot2_f32_bf16 v34, v54, v14, v34
  v_dot2_f32_bf16 v35, v58, v14, v35
  v_dot2_f32_bf16 v32, v47, v15, v32
  v_dot2_f32_bf16 v33, v51, v15, v33
  v_dot2_f32_bf16 v34, v55, v15, v34
  v_dot2_f32_bf16 v35, v59, v15, v35
  v_add_f32_dpp v36, v32, v32 row_ror:8 row_mask:0xf bank_mask:0x3
  s_nop 0
  v_add_f32_dpp v37, v34, v34 row_ror:8 row_mask:0xf bank_mask:0x3
  v_add_f32_dpp v36, v33, v33 row_ror:8 row_mask:0xf bank_mask:0xc
  v_add_f32_dpp v37, v35, v35 row_ror:8 row_mask:0xf bank_mask:0xc
  s_nop 0
  v_add_f32_dpp v38, v36, v36 row_half_mirror row_mask:0xf bank_mask:0x5
  v_add_f32_dpp v38, v37, v37 row_half_mirror row_mask:0xf bank_mask:0xa
  s_nop 1
  v_add_f32_dpp v38, v38, v38 quad_perm:[1,0,3,2] row_mask:0xf bank_mask:0xf
  s_nop 1
  v_add_f32_dpp v16, v38, v38 quad_perm:[2,3,0,1] row_mask:0xf bank_mask:0xf
  s_waitcnt vmcnt(2)
  buffer_load_dwordx4 v[160:163], v4, s[28:31], s70 offen offset:1024 nt
  v_dot2_f32_bf16 v32, v60, v12, 0
  v_dot2_f32_bf16 v33, v64, v12, 0
  v_dot2_f32_bf16 v34, v68, v12, 0
  v_dot2_f32_bf16 v35, v72, v12, 0
  v_dot2_f32_bf16 v32, v61, v13, v32
  v_dot2_f32_bf16 v33, v65, v13, v33
  v_dot2_f32_bf16 v34, v69, v13, v34
  v_dot2_f32_bf16 v35, v73, v13, v35
  v_dot2_f32_bf16 v32, v62, v14, v32
  v_dot2_f32_bf16 v33, v66, v14, v33
  v_dot2_f32_bf16 v34, v70, v14, v34
  v_dot2_f32_bf16 v35, v74, v14, v35
  v_dot2_f32_bf16 v32, v63, v15, v32
  v_dot2_f32_bf16 v33, v67, v15, v33
  v_dot2_f32_bf16 v34, v71, v15, v34
  v_dot2_f32_bf16 v35, v75, v15, v35
  v_add_f32_dpp v36, v32, v32 row_ror:8 row_mask:0xf bank_mask:0x3
  s_nop 0
  v_add_f32_dpp v37, v34, v34 row_ror:8 row_mask:0xf bank_mask:0x3
  v_add_f32_dpp v36, v33, v33 row_ror:8 row_mask:0xf bank_mask:0xc
  v_add_f32_dpp v37, v35, v35 row_ror:8 row_mask:0xf bank_mask:0xc
  s_nop 0
  v_add_f32_dpp v38, v36, v36 row_half_mirror row_mask:0xf bank_mask:0x5
  v_add_f32_dpp v38, v37, v37 row_half_mirror row_mask:0xf bank_mask:0xa
  s_nop 1
  v_add_f32_dpp v38, v38, v38 quad_perm:[1,0,3,2] row_mask:0xf bank_mask:0xf
  s_nop 1
  v_add_f32_dpp v38, v38, v38 quad_perm:[2,3,0,1] row_mask:0xf bank_mask:0xf
  v_cndmask_b32 v16, v16, v38, s[80:81]
  s_waitcnt vmcnt(2)
  buffer_load_dwordx4 v[164:167], v4, s[28:31], s70 offen offset:2048 nt
  v_dot2_f32_bf16 v32, v76, v12, 0
  v_dot2_f32_bf16 v33, v80, v12, 0
  v_dot2_f32_bf16 v34, v84, v12, 0
  v_dot2_f32_bf16 v35, v88, v12, 0
  v_dot2_f32_bf16 v32, v77, v13, v32
  v_dot2_f32_bf16 v33, v81, v13, v33
  v_dot2_f32_bf16 v34, v85, v13, v34
  v_dot2_f32_bf16 v35, v89, v13, v35
  v_dot2_f32_bf16 v32, v78, v14, v32
  v_dot2_f32_bf16 v33, v82, v14, v33
  v_dot2_f32_bf16 v34, v86, v14, v34
  v_dot2_f32_bf16 v35, v90, v14, v35
  v_dot2_f32_bf16 v32, v79, v15, v32
  v_dot2_f32_bf16 v33, v83, v15, v33
  v_dot2_f32_bf16 v34, v87, v15, v34
  v_dot2_f32_bf16 v35, v91, v15, v35
  v_add_f32_dpp v36, v32, v32 row_ror:8 row_mask:0xf bank_mask:0x3
  s_nop 0
  v_add_f32_dpp v37, v34, v34 row_ror:8 row_mask:0xf bank_mask:0x3
  v_add_f32_dpp v36, v33, v33 row_ror:8 row_mask:0xf bank_mask:0xc
  v_add_f32_dpp v37, v35, v35 row_ror:8 row_mask:0xf bank_mask:0xc
  s_nop 0
  v_add_f32_dpp v38, v36, v36 row_half_mirror row_mask:0xf bank_mask:0x5
  v_add_f32_dpp v38, v37, v37 row_half_mirror row_mask:0xf bank_mask:0xa
  s_nop 1
  v_add_f32_dpp v38, v38, v38 quad_perm:[1,0,3,2] row_mask:0xf bank_mask:0xf
  s_nop 1
  v_add_f32_dpp v38, v38, v38 quad_perm:[2,3,0,1] row_mask:0xf bank_mask:0xf
  v_cndmask_b32 v16, v16, v38, s[82:83]
  s_waitcnt vmcnt(2)
  buffer_load_dwordx4 v[44:47], v4, s[28:31], s70 offen offset:3072 nt
  s_add_u32 s70, s70, 0x8000
  s_and_b32 s70, s70, 0x7ffff
  v_dot2_f32_bf16 v32, v92, v12, 0
  v_dot2_f32_bf16 v33, v96, v12, 0
  v_dot2_f32_bf16 v34, v100, v12, 0
  v_dot2_f32_bf16 v35, v104, v12, 0
  v_dot2_f32_bf16 v32, v93, v13, v32
  v_dot2_f32_bf16 v33, v97, v13, v33
  v_dot2_f32_bf16 v34, v101, v13, v34
  v_dot2_f32_bf16 v35, v105, v13, v35
  v_dot2_f32_bf16 v32, v94, v14, v32
  v_dot2_f32_bf16 v33, v98, v14, v33
  v_dot2_f32_bf16 v34, v102, v14, v34
  v_dot2_f32_bf16 v35, v106, v14, v35
  v_dot2_f32_bf16 v32, v95, v15, v32
  v_dot2_f32_bf16 v33, v99, v15, v33
  v_dot2_f32_bf16 v34, v103, v15, v34
  v_dot2_f32_bf16 v35, v107, v15, v35
  v_add_f32_dpp v36, v32, v32 row_ror:8 row_mask:0xf bank_mask:0x3
  s_nop 0
  v_add_f32_dpp v37, v34, v34 row_ror:8 row_mask:0xf bank_mask:0x3
  v_add_f32_dpp v36, v33, v33 row_ror:8 row_mask:0xf bank_mask:0xc
  v_add_f32_dpp v37, v35, v35 row_ror:8 row_mask:0xf bank_mask:0xc
  s_nop 0
  v_add_f32_dpp v38, v36, v36 row_half_mirror row_mask:0xf bank_mask:0x5
  v_add_f32_dpp v38, v37, v37 row_half_mirror row_mask:0xf bank_mask:0xa
  s_nop 1
  v_add_f32_dpp v38, v38, v38 quad_perm:[1,0,3,2] row_mask:0xf bank_mask:0xf
  s_nop 1
  v_add_f32_dpp v38, v38, v38 quad_perm:[2,3,0,1] row_mask:0xf bank_mask:0xf
  v_cndmask_b32 v16, v16, v38, s[84:85]
  s_waitcnt vmcnt(2)
  buffer_load_dwordx4 v[48:51], v4, s[28:31], s70 offen offset:0 nt
  v_dot2_f32_bf16 v32, v108, v12, 0
  v_dot2_f32_bf16 v33, v112, v12, 0
  v_dot2_f32_bf16 v34, v116, v12, 0
  v_dot2_f32_bf16 v35, v120, v12, 0
  v_dot2_f32_bf16 v32, v109, v13, v32
  v_dot2_f32_bf16 v33, v113, v13, v33
  v_dot2_f32_bf16 v34, v117, v13, v34
  v_dot2_f32_bf16 v35, v121, v13, v35
  v_dot2_f32_bf16 v32, v110, v14, v32
  v_dot2_f32_bf16 v33, v114, v14, v33
  v_dot2_f32_bf16 v34, v118, v14, v34
  v_dot2_f32_bf16 v35, v122, v14, v35
  v_dot2_f32_bf16 v32, v111, v15, v32
  v_dot2_f32_bf16 v33, v115, v15, v33
  v_dot2_f32_bf16 v34, v119, v15, v34
  v_dot2_f32_bf16 v35, v123, v15, v35
  v_add_f32_dpp v36, v32, v32 row_ror:8 row_mask:0xf bank_mask:0x3
  s_nop 0
  v_add_f32_dpp v37, v34, v34 row_ror:8 row_mask:0xf bank_mask:0x3
  v_add_f32_dpp v36, v33, v33 row_ror:8 row_mask:0xf bank_mask:0xc
  v_add_f32_dpp v37, v35, v35 row_ror:8 row_mask:0xf bank_mask:0xc
  s_nop 0
  v_add_f32_dpp v38, v36, v36 row_half_mirror row_mask:0xf bank_mask:0x5
  v_add_f32_dpp v38, v37, v37 row_half_mirror row_mask:0xf bank_mask:0xa
  s_nop 1
  v_add_f32_dpp v38, v38, v38 quad_perm:[1,0,3,2] row_mask:0xf bank_mask:0xf
  s_nop 1
  v_add_f32_dpp v17, v38, v38 quad_perm:[2,3,0,1] row_mask:0xf bank_mask:0xf
  s_waitcnt vmcnt(2)
  buffer_load_dwordx4 v[52:55], v4, s[28:31], s70 offen offset:1024 nt
  v_dot2_f32_bf16 v32, v124, v12, 0
  v_dot2_f32_bf16 v33, v128, v12, 0
  v_dot2_f32_bf16 v34, v132, v12, 0
  v_dot2_f32_bf16 v35, v136, v12, 0
  v_dot2_f32_bf16 v32, v125, v13, v32
  v_dot2_f32_bf16 v33, v129, v13, v33
  v_dot2_f32_bf16 v34, v133, v13, v34
  v_dot2_f32_bf16 v35, v137, v13, v35
  v_dot2_f32_bf16 v32, v126, v14, v32
  v_dot2_f32_bf16 v33, v130, v14, v33
  v_dot2_f32_bf16 v34, v134, v14, v34
  v_dot2_f32_bf16 v35, v138, v14, v35
  v_dot2_f32_bf16 v32, v127, v15, v32
  v_dot2_f32_bf16 v33, v131, v15, v33
  v_dot2_f32_bf16 v34, v135, v15, v34
  v_dot2_f32_bf16 v35, v139, v15, v35
  v_add_f32_dpp v36, v32, v32 row_ror:8 row_mask:0xf bank_mask:0x3
  s_nop 0
  v_add_f32_dpp v37, v34, v34 row_ror:8 row_mask:0xf bank_mask:0x3
  v_add_f32_dpp v36, v33, v33 row_ror:8 row_mask:0xf bank_mask:0xc
  v_add_f32_dpp v37, v35, v35 row_ror:8 row_mask:0xf bank_mask:0xc
  s_nop 0
  v_add_f32_dpp v38, v36, v36 row_half_mirror row_mask:0xf bank_mask:0x5
  v_add_f32_dpp v38, v37, v37 row_half_mirror row_mask:0xf bank_mask:0xa
  s_nop 1
  v_add_f32_dpp v38, v38, v38 quad_perm:[1,0,3,2] row_mask:0xf bank_mask:0xf
  s_nop 1
  v_add_f32_dpp v38, v38, v38 quad_perm:[2,3,0,1] row_mask:0xf bank_mask:0xf
  v_cndmask_b32 v17, v17, v38, s[80:81]
  s_waitcnt vmcnt(2)
  buffer_load_dwordx4 v[56:59], v4, s[28:31], s70 offen offset:2048 nt
  v_dot2_f32_bf16 v32, v140, v12, 0
  v_dot2_f32_bf16 v33, v144, v12, 0
  v_dot2_f32_bf16 v34, v148, v12, 0
  v_dot2_f32_bf16 v35, v152, v12, 0
  v_dot2_f32_bf16 v32, v141, v13, v32
  v_dot2_f32_bf16 v33, v145, v13, v33
  v_dot2_f32_bf16 v34, v149, v13, v34
  v_dot2_f32_bf16 v35, v153, v13, v35
  v_dot2_f32_bf16 v32, v142, v14, v32
  v_dot2_f32_bf16 v33, v146, v14, v33
  v_dot2_f32_bf16 v34, v150, v14, v34
  v_dot2_f32_bf16 v35, v154, v14, v35
  v_dot2_f32_bf16 v32, v143, v15, v32
  v_dot2_f32_bf16 v33, v147, v15, v33
  v_dot2_f32_bf16 v34, v151, v15, v34
  v_dot2_f32_bf16 v35, v155, v15, v35
  v_add_f32_dpp v36, v32, v32 row_ror:8 row_mask:0xf bank_mask:0x3
  s_nop 0
  v_add_f32_dpp v37, v34, v34 row_ror:8 row_mask:0xf bank_mask:0x3
  v_add_f32_dpp v36, v33, v33 row_ror:8 row_mask:0xf bank_mask:0xc
  v_add_f32_dpp v37, v35, v35 row_ror:8 row_mask:0xf bank_mask:0xc
  s_nop 0
  v_add_f32_dpp v38, v36, v36 row_half_mirror row_mask:0xf bank_mask:0x5
  v_add_f32_dpp v38, v37, v37 row_half_mirror row_mask:0xf bank_mask:0xa
  s_nop 1
  v_add_f32_dpp v38, v38, v38 quad_perm:[1,0,3,2] row_mask:0xf bank_mask:0xf
  s_nop 1
  v_add_f32_dpp v38, v38, v38 quad_perm:[2,3,0,1] row_mask:0xf bank_mask:0xf
  v_cndmask_b32 v17, v17, v38, s[82:83]
  s_waitcnt vmcnt(2)
  buffer_load_dwordx4 v[60:63], v4, s[28:31], s70 offen offset:3072 nt
  s_add_u32 s70, s70, 0x8000
  s_and_b32 s70, s70, 0x7ffff
  v_dot2_f32_bf16 v32, v156, v12, 0
  v_dot2_f32_bf16 v33, v160, v12, 0
  v_dot2_f32_bf16 v34, v164, v12, 0
  v_dot2_f32_bf16 v35, v44, v12, 0
  v_dot2_f32_bf16 v32, v157, v13, v32
  v_dot2_f32_bf16 v33, v161, v13, v33
  v_dot2_f32_bf16 v34, v165, v13, v34
  v_dot2_f32_bf16 v35, v45, v13, v35
  v_dot2_f32_bf16 v32, v158, v14, v32
  v_dot2_f32_bf16 v33, v162, v14, v33
  v_dot2_f32_bf16 v34, v166, v14, v34
  v_dot2_f32_bf16 v35, v46, v14, v35
  v_dot2_f32_bf16 v32, v159, v15, v32
  v_dot2_f32_bf16 v33, v163, v15, v33
  v_dot2_f32_bf16 v34, v167, v15, v34
  v_dot2_f32_bf16 v35, v47, v15, v35
  v_add_f32_dpp v36, v32, v32 row_ror:8 row_mask:0xf bank_mask:0x3
  s_nop 0
  v_add_f32_dpp v37, v34, v34 row_ror:8 row_mask:0xf bank_mask:0x3
  v_add_f32_dpp v36, v33, v33 row_ror:8 row_mask:0xf bank_mask:0xc
  v_add_f32_dpp v37, v35, v35 row_ror:8 row_mask:0xf bank_mask:0xc
  s_nop 0
  v_add_f32_dpp v38, v36, v36 row_half_mirror row_mask:0xf bank_mask:0x5
  v_add_f32_dpp v38, v37, v37 row_half_mirror row_mask:0xf bank_mask:0xa
  s_nop 1
  v_add_f32_dpp v38, v38, v38 quad_perm:[1,0,3,2] row_mask:0xf bank_mask:0xf
  s_nop 1
  v_add_f32_dpp v38, v38, v38 quad_perm:[2,3,0,1] row_mask:0xf bank_mask:0xf
  v_cndmask_b32 v17, v17, v38, s[84:85]
  s_waitcnt vmcnt(2)
  buffer_load_dwordx4 v[64:67], v4, s[28:31], s70 offen offset:0 nt
  s_waitcnt vmcnt(2)
  buffer_load_dwordx4 v[68:71], v4, s[28:31], s70 offen offset:1024 nt
  s_waitcnt vmcnt(2)
  buffer_load_dwordx4 v[72:75], v4, s[28:31], s70 offen offset:2048 nt
  v_dot2_f32_bf16 v32, v48, v12, 0
  v_dot2_f32_bf16 v33, v52, v12, 0
  v_dot2_f32_bf16 v34, v56, v12, 0
  v_dot2_f32_bf16 v35, v60, v12, 0
  v_dot2_f32_bf16 v32, v49, v13, v32
  v_dot2_f32_bf16 v33, v53, v13, v33
  v_dot2_f32_bf16 v34, v57, v13, v34
  v_dot2_f32_bf16 v35, v61, v13, v35
  v_dot2_f32_bf16 v32, v50, v14, v32
  v_dot2_f32_bf16 v33, v54, v14, v33
  v_dot2_f32_bf16 v34, v58, v14, v34
  v_dot2_f32_bf16 v35, v62, v14, v35
  v_dot2_f32_bf16 v32, v51, v15, v32
  v_dot2_f32_bf16 v33, v55, v15, v33
  v_dot2_f32_bf16 v34, v59, v15, v34
  v_dot2_f32_bf16 v35, v63, v15, v35
  v_add_f32_dpp v36, v32, v32 row_ror:8 row_mask:0xf bank_mask:0x3
  s_nop 0
  v_add_f32_dpp v37, v34, v34 row_ror:8 row_mask:0xf bank_mask:0x3
  v_add_f32_dpp v36, v33, v33 row_ror:8 row_mask:0xf bank_mask:0xc
  v_add_f32_dpp v37, v35, v35 row_ror:8 row_mask:0xf bank_mask:0xc
  s_nop 0
  v_add_f32_dpp v38, v36, v36 row_half_mirror row_mask:0xf bank_mask:0x5
  v_add_f32_dpp v38, v37, v37 row_half_mirror row_mask:0xf bank_mask:0xa
  s_nop 1
  v_add_f32_dpp v38, v38, v38 quad_perm:[1,0,3,2] row_mask:0xf bank_mask:0xf
  s_nop 1
  v_add_f32_dpp v18, v38, v38 quad_perm:[2,3,0,1] row_mask:0xf bank_mask:0xf
  s_waitcnt vmcnt(2)
  buffer_load_dwordx4 v[76:79], v4, s[28:31], s70 offen offset:3072 nt
  s_add_u32 s70, s70, 0x8000
  s_and_b32 s70, s70, 0x7ffff
  s_waitcnt vmcnt(2)
  buffer_load_dwordx4 v[80:83], v4, s[28:31], s70 offen offset:0 nt
  s_waitcnt vmcnt(2)
  buffer_load_dwordx4 v[84:87], v4, s[28:31], s70 offen offset:1024 nt
  s_waitcnt vmcnt(2)
  buffer_load_dwordx4 v[88:91], v4, s[28:31], s70 offen offset:2048 nt
  v_dot2_f32_bf16 v32, v64, v12, 0
  v_dot2_f32_bf16 v33, v68, v12, 0
  v_dot2_f32_bf16 v34, v72, v12, 0
  v_dot2_f32_bf16 v35, v76, v12, 0
  v_dot2_f32_bf16 v32, v65, v13, v32
  v_dot2_f32_bf16 v33, v69, v13, v33
  v_dot2_f32_bf16 v34, v73, v13, v34
  v_dot2_f32_bf16 v35, v77, v13, v35
  v_dot2_f32_bf16 v32, v66, v14, v32
  v_dot2_f32_bf16 v33, v70, v14, v33
  v_dot2_f32_bf16 v34, v74, v14, v34
  v_dot2_f32_bf16 v35, v78, v14, v35
  v_dot2_f32_bf16 v32, v67, v15, v32
  v_dot2_f32_bf16 v33, v71, v15, v33
  v_dot2_f32_bf16 v34, v75, v15, v34
  v_dot2_f32_bf16 v35, v79, v15, v35
  v_add_f32_dpp v36, v32, v32 row_ror:8 row_mask:0xf bank_mask:0x3
  s_nop 0
  v_add_f32_dpp v37, v34, v34 row_ror:8 row_mask:0xf bank_mask:0x3
  v_add_f32_dpp v36, v33, v33 row_ror:8 row_mask:0xf bank_mask:0xc
  v_add_f32_dpp v37, v35, v35 row_ror:8 row_mask:0xf bank_mask:0xc
  s_nop 0
  v_add_f32_dpp v38, v36, v36 row_half_mirror row_mask:0xf bank_mask:0x5
  v_add_f32_dpp v38, v37, v37 row_half_mirror row_mask:0xf bank_mask:0xa
  s_nop 1
  v_add_f32_dpp v38, v38, v38 quad_perm:[1,0,3,2] row_mask:0xf bank_mask:0xf
  s_nop 1
  v_add_f32_dpp v38, v38, v38 quad_perm:[2,3,0,1] row_mask:0xf bank_mask:0xf
  v_cndmask_b32 v18, v18, v38, s[80:81]
  s_waitcnt vmcnt(2)
  buffer_load_dwordx4 v[92:95], v4, s[28:31], s70 offen offset:3072 nt
  s_add_u32 s70, s70, 0x8000
  s_and_b32 s70, s70, 0x7ffff
  s_waitcnt vmcnt(2)
  buffer_load_dwordx4 v[96:99], v4, s[28:31], s70 offen offset:0 nt
  s_waitcnt vmcnt(2)
  buffer_load_dwordx4 v[100:103], v4, s[28:31], s70 offen offset:1024 nt
  s_waitcnt vmcnt(2)
  buffer_load_dwordx4 v[104:107], v4, s[28:31], s70 offen offset:2048 nt
  v_dot2_f32_bf16 v32, v80, v12, 0
  v_dot2_f32_bf16 v33, v84, v12, 0
  v_dot2_f32_bf16 v34, v88, v12, 0
  v_dot2_f32_bf16 v35, v92, v12, 0
  v_dot2_f32_bf16 v32, v81, v13, v32
  v_dot2_f32_bf16 v33, v85, v13, v33
  v_dot2_f32_bf16 v34, v89, v13, v34
  v_dot2_f32_bf16 v35, v93, v13, v35
  v_dot2_f32_bf16 v32, v82, v14, v32
  v_dot2_f32_bf16 v33, v86, v14, v33
  v_dot2_f32_bf16 v34, v90, v14, v34
  v_dot2_f32_bf16 v35, v94, v14, v35
  v_dot2_f32_bf16 v32, v83, v15, v32
  v_dot2_f32_bf16 v33, v87, v15, v33
  v_dot2_f32_bf16 v34, v91, v15, v34
  v_dot2_f32_bf16 v35, v95, v15, v35
  v_add_f32_dpp v36, v32, v32 row_ror:8 row_mask:0xf bank_mask:0x3
  s_nop 0
  v_add_f32_dpp v37, v34, v34 row_ror:8 row_mask:0xf bank_mask:0x3
  v_add_f32_dpp v36, v33, v33 row_ror:8 row_mask:0xf bank_mask:0xc
  v_add_f32_dpp v37, v35, v35 row_ror:8 row_mask:0xf bank_mask:0xc
  s_nop 0
  v_add_f32_dpp v38, v36, v36 row_half_mirror row_mask:0xf bank_mask:0x5
  v_add_f32_dpp v38, v37, v37 row_half_mirror row_mask:0xf bank_mask:0xa
  s_nop 1
  v_add_f32_dpp v38, v38, v38 quad_perm:[1,0,3,2] row_mask:0xf bank_mask:0xf
  s_nop 1
  v_add_f32_dpp v38, v38, v38 quad_perm:[2,3,0,1] row_mask:0xf bank_mask:0xf
  v_cndmask_b32 v18, v18, v38, s[82:83]
  s_waitcnt vmcnt(2)
  buffer_load_dwordx4 v[108:111], v4, s[28:31], s70 offen offset:3072 nt
  s_add_u32 s70, s70, 0x8000
  s_and_b32 s70, s70, 0x7ffff
  s_waitcnt vmcnt(2)
  buffer_load_dwordx4 v[112:115], v4, s[28:31], s70 offen offset:0 nt
  s_waitcnt vmcnt(2)
  buffer_load_dwordx4 v[116:119], v4, s[28:31], s70 offen offset:1024 nt
  s_waitcnt vmcnt(2)
  buffer_load_dwordx4 v[120:123], v4, s[28:31], s70 offen offset:2048 nt
  v_dot2_f32_bf16 v32, v96, v12, 0
  v_dot2_f32_bf16 v33, v100, v12, 0
  v_dot2_f32_bf16 v34, v104, v12, 0
  v_dot2_f32_bf16 v35, v108, v12, 0
  v_dot2_f32_bf16 v32, v97, v13, v32
  v_dot2_f32_bf16 v33, v101, v13, v33
  v_dot2_f32_bf16 v34, v105, v13, v34
  v_dot2_f32_bf16 v35, v109, v13, v35
  v_dot2_f32_bf16 v32, v98, v14, v32
  v_dot2_f32_bf16 v33, v102, v14, v33
  v_dot2_f32_bf16 v34, v106, v14, v34
  v_dot2_f32_bf16 v35, v110, v14, v35
  v_dot2_f32_bf16 v32, v99, v15, v32
  v_dot2_f32_bf16 v33, v103, v15, v33
  v_dot2_f32_bf16 v34, v107, v15, v34
  v_dot2_f32_bf16 v35, v111, v15, v35
  v_add_f32_dpp v36, v32, v32 row_ror:8 row_mask:0xf bank_mask:0x3
  s_nop 0
  v_add_f32_dpp v37, v34, v34 row_ror:8 row_mask:0xf bank_mask:0x3
  v_add_f32_dpp v36, v33, v33 row_ror:8 row_mask:0xf bank_mask:0xc
  v_add_f32_dpp v37, v35, v35 row_ror:8 row_mask:0xf bank_mask:0xc
  s_nop 0
  v_add_f32_dpp v38, v36, v36 row_half_mirror row_mask:0xf bank_mask:0x5
  v_add_f32_dpp v38, v37, v37 row_half_mirror row_mask:0xf bank_mask:0xa
  s_nop 1
  v_add_f32_dpp v38, v38, v38 quad_perm:[1,0,3,2] row_mask:0xf bank_mask:0xf
  s_nop 1
  v_add_f32_dpp v38, v38, v38 quad_perm:[2,3,0,1] row_mask:0xf bank_mask:0xf
  v_cndmask_b32 v18, v18, v38, s[84:85]
  s_waitcnt vmcnt(2)
  buffer_load_dwordx4 v[124:127], v4, s[28:31], s70 offen offset:3072 nt
  s_add_u32 s70, s70, 0x8000
  s_and_b32 s70, s70, 0x7ffff
  s_waitcnt vmcnt(2)
  buffer_load_dwordx4 v[128:131], v4, s[28:31], s70 offen offset:0 nt
  s_waitcnt vmcnt(2)
  buffer_load_dwordx4 v[132:135], v4, s[28:31], s70 offen offset:1024 nt
  s_waitcnt vmcnt(2)
  buffer_load_dwordx4 v[136:139], v4, s[28:31], s70 offen offset:2048 nt
  v_dot2_f32_bf16 v32, v112, v12, 0
  v_dot2_f32_bf16 v33, v116, v12, 0
  v_dot2_f32_bf16 v34, v120, v12, 0
  v_dot2_f32_bf16 v35, v124, v12, 0
  v_dot2_f32_bf16 v32, v113, v13, v32
  v_dot2_f32_bf16 v33, v117, v13, v33
  v_dot2_f32_bf16 v34, v121, v13, v34
  v_dot2_f32_bf16 v35, v125, v13, v35
  v_dot2_f32_bf16 v32, v114, v14, v32
  v_dot2_f32_bf16 v33, v118, v14, v33
  v_dot2_f32_bf16 v34, v122, v14, v34
  v_dot2_f32_bf16 v35, v126, v14, v35
  v_dot2_f32_bf16 v32, v115, v15, v32
  v_dot2_f32_bf16 v33, v119, v15, v33
  v_dot2_f32_bf16 v34, v123, v15, v34
  v_dot2_f32_bf16 v35, v127, v15, v35
  v_add_f32_dpp v36, v32, v32 row_ror:8 row_mask:0xf bank_mask:0x3
  s_nop 0
  v_add_f32_dpp v37, v34, v34 row_ror:8 row_mask:0xf bank_mask:0x3
  v_add_f32_dpp v36, v33, v33 row_ror:8 row_mask:0xf bank_mask:0xc
  v_add_f32_dpp v37, v35, v35 row_ror:8 row_mask:0xf bank_mask:0xc
  s_nop 0
  v_add_f32_dpp v38, v36, v36 row_half_mirror row_mask:0xf bank_mask:0x5
  v_add_f32_dpp v38, v37, v37 row_half_mirror row_mask:0xf bank_mask:0xa
  s_nop 1
  v_add_f32_dpp v38, v38, v38 quad_perm:[1,0,3,2] row_mask:0xf bank_mask:0xf
  s_nop 1
  v_add_f32_dpp v19, v38, v38 quad_perm:[2,3,0,1] row_mask:0xf bank_mask:0xf
  s_waitcnt vmcnt(2)
  buffer_load_dwordx4 v[140:143], v4, s[28:31], s70 offen offset:3072 nt
  s_add_u32 s70, s70, 0x8000
  s_and_b32 s70, s70, 0x7ffff
  s_waitcnt vmcnt(2)
  buffer_load_dwordx4 v[144:147], v4, s[28:31], s70 offen offset:0 nt
  s_waitcnt vmcnt(2)
  buffer_load_dwordx4 v[148:151], v4, s[28:31], s70 offen offset:1024 nt
  s_waitcnt vmcnt(2)
  buffer_load_dwordx4 v[152:155], v4, s[28:31], s70 offen offset:2048 nt
  v_dot2_f32_bf16 v32, v128, v12, 0
  v_dot2_f32_bf16 v33, v132, v12, 0
  v_dot2_f32_bf16 v34, v136, v12, 0
  v_dot2_f32_bf16 v35, v140, v12, 0
  v_dot2_f32_bf16 v32, v129, v13, v32
  v_dot2_f32_bf16 v33, v133, v13, v33
  v_dot2_f32_bf16 v34, v137, v13, v34
  v_dot2_f32_bf16 v35, v141, v13, v35
  v_dot2_f32_bf16 v32, v130, v14, v32
  v_dot2_f32_bf16 v33, v134, v14, v33
  v_dot2_f32_bf16 v34, v138, v14, v34
  v_dot2_f32_bf16 v35, v142, v14, v35
  v_dot2_f32_bf16 v32, v131, v15, v32
  v_dot2_f32_bf16 v33, v135, v15, v33
  v_dot2_f32_bf16 v34, v139, v15, v34
  v_dot2_f32_bf16 v35, v143, v15, v35
  v_add_f32_dpp v36, v32, v32 row_ror:8 row_mask:0xf bank_mask:0x3
  s_nop 0
  v_add_f32_dpp v37, v34, v34 row_ror:8 row_mask:0xf bank_mask:0x3
  v_add_f32_dpp v36, v33, v33 row_ror:8 row_mask:0xf bank_mask:0xc
  v_add_f32_dpp v37, v35, v35 row_ror:8 row_mask:0xf bank_mask:0xc
  s_nop 0
  v_add_f32_dpp v38, v36, v36 row_half_mirror row_mask:0xf bank_mask:0x5
  v_add_f32_dpp v38, v37, v37 row_half_mirror row_mask:0xf bank_mask:0xa
  s_nop 1
  v_add_f32_dpp v38, v38, v38 quad_perm:[1,0,3,2] row_mask:0xf bank_mask:0xf
  s_nop 1
  v_add_f32_dpp v38, v38, v38 quad_perm:[2,3,0,1] row_mask:0xf bank_mask:0xf
  v_cndmask_b32 v19, v19, v38, s[80:81]
  s_waitcnt vmcnt(2)
  buffer_load_dwordx4 v[156:159], v4, s[28:31], s70 offen offset:3072 nt
  s_add_u32 s70, s70, 0x8000
  s_and_b32 s70, s70, 0x7ffff
  s_waitcnt vmcnt(2)
  buffer_load_dwordx4 v[160:163], v4, s[28:31], s70 offen offset:0 nt
  s_waitcnt vmcnt(2)
  buffer_load_dwordx4 v[164:167], v4, s[28:31], s70 offen offset:1024 nt
  s_waitcnt vmcnt(2)
  buffer_load_dwordx4 v[44:47], v4, s[28:31], s70 offen offset:2048 nt
  v_dot2_f32_bf16 v32, v144, v12, 0
  v_dot2_f32_bf16 v33, v148, v12, 0
  v_dot2_f32_bf16 v34, v152, v12, 0
  v_dot2_f32_bf16 v35, v156, v12, 0
  v_dot2_f32_bf16 v32, v145, v13, v32
  v_dot2_f32_bf16 v33, v149, v13, v33
  v_dot2_f32_bf16 v34, v153, v13, v34
  v_dot2_f32_bf16 v35, v157, v13, v35
  v_dot2_f32_bf16 v32, v146, v14, v32
  v_dot2_f32_bf16 v33, v150, v14, v33
  v_dot2_f32_bf16 v34, v154, v14, v34
  v_dot2_f32_bf16 v35, v158, v14, v35
  v_dot2_f32_bf16 v32, v147, v15, v32
  v_dot2_f32_bf16 v33, v151, v15, v33
  v_dot2_f32_bf16 v34, v155, v15, v34
  v_dot2_f32_bf16 v35, v159, v15, v35
  v_add_f32_dpp v36, v32, v32 row_ror:8 row_mask:0xf bank_mask:0x3
  s_nop 0
  v_add_f32_dpp v37, v34, v34 row_ror:8 row_mask:0xf bank_mask:0x3
  v_add_f32_dpp v36, v33, v33 row_ror:8 row_mask:0xf bank_mask:0xc
  v_add_f32_dpp v37, v35, v35 row_ror:8 row_mask:0xf bank_mask:0xc
  s_nop 0
  v_add_f32_dpp v38, v36, v36 row_half_mirror row_mask:0xf bank_mask:0x5
  v_add_f32_dpp v38, v37, v37 row_half_mirror row_mask:0xf bank_mask:0xa
  s_nop 1
  v_add_f32_dpp v38, v38, v38 quad_perm:[1,0,3,2] row_mask:0xf bank_mask:0xf
  s_nop 1
  v_add_f32_dpp v38, v38, v38 quad_perm:[2,3,0,1] row_mask:0xf bank_mask:0xf
  v_cndmask_b32 v19, v19, v38, s[82:83]
  s_waitcnt vmcnt(2)
  buffer_load_dwordx4 v[48:51], v4, s[28:31], s70 offen offset:3072 nt
  s_add_u32 s70, s70, 0x8000
  s_and_b32 s70, s70, 0x7ffff
  s_waitcnt vmcnt(2)
  buffer_load_dwordx4 v[52:55], v4, s[32:35], s70 offen offset:0 nt
  s_waitcnt vmcnt(2)
  buffer_load_dwordx4 v[56:59], v4, s[32:35], s70 offen offset:1024 nt
  s_waitcnt vmcnt(2)
  buffer_load_dwordx4 v[60:63], v4, s[32:35], s70 offen offset:2048 nt
  v_dot2_f32_bf16 v32, v160, v12, 0
  v_dot2_f32_bf16 v33, v164, v12, 0
  v_dot2_f32_bf16 v34, v44, v12, 0
  v_dot2_f32_bf16 v35, v48, v12, 0
  v_dot2_f32_bf16 v32, v161, v13, v32
  v_dot2_f32_bf16 v33, v165, v13, v33
  v_dot2_f32_bf16 v34, v45, v13, v34
  v_dot2_f32_bf16 v35, v49, v13, v35
  v_dot2_f32_bf16 v32, v162, v14, v32
  v_dot2_f32_bf16 v33, v166, v14, v33
  v_dot2_f32_bf16 v34, v46, v14, v34
  v_dot2_f32_bf16 v35, v50, v14, v35
  v_dot2_f32_bf16 v32, v163, v15, v32
  v_dot2_f32_bf16 v33, v167, v15, v33
  v_dot2_f32_bf16 v34, v47, v15, v34
  v_dot2_f32_bf16 v35, v51, v15, v35
  v_add_f32_dpp v36, v32, v32 row_ror:8 row_mask:0xf bank_mask:0x3
  s_nop 0
  v_add_f32_dpp v37, v34, v34 row_ror:8 row_mask:0xf bank_mask:0x3
  v_add_f32_dpp v36, v33, v33 row_ror:8 row_mask:0xf bank_mask:0xc
  v_add_f32_dpp v37, v35, v35 row_ror:8 row_mask:0xf bank_mask:0xc
  s_nop 0
  v_add_f32_dpp v38, v36, v36 row_half_mirror row_mask:0xf bank_mask:0x5
  v_add_f32_dpp v38, v37, v37 row_half_mirror row_mask:0xf bank_mask:0xa
  s_nop 1
  v_add_f32_dpp v38, v38, v38 quad_perm:[1,0,3,2] row_mask:0xf bank_mask:0xf
  s_nop 1
  v_add_f32_dpp v38, v38, v38 quad_perm:[2,3,0,1] row_mask:0xf bank_mask:0xf
  v_cndmask_b32 v19, v19, v38, s[84:85]
  s_waitcnt vmcnt(2)
  buffer_load_dwordx4 v[64:67], v4, s[32:35], s70 offen offset:3072 nt
  s_add_u32 s70, s70, 0x8000
  s_and_b32 s70, s70, 0x7ffff
  v_cvt_pk_bf16_f32 v16, v16, v16
  v_cvt_pk_bf16_f32 v17, v17, v17
  v_cvt_pk_bf16_f32 v18, v18, v18
  v_cvt_pk_bf16_f32 v19, v19, v19
  v_and_b32 v16, 0xffff0000, v16
  v_and_b32 v17, 0xffff0000, v17
  v_and_b32 v18, 0xffff0000, v18
  v_and_b32 v19, 0xffff0000, v19
  v_mul_f32 v16, 0x3db504f3, v16
  v_mul_f32 v17, 0x3db504f3, v17
  v_mul_f32 v18, 0x3db504f3, v18
  v_mul_f32 v19, 0x3db504f3, v19
  v_cvt_pk_bf16_f32 v16, v16, v16
  v_cvt_pk_bf16_f32 v17, v17, v17
  v_cvt_pk_bf16_f32 v18, v18, v18
  v_cvt_pk_bf16_f32 v19, v19, v19
  v_and_b32 v16, 0xffff0000, v16
  v_and_b32 v17, 0xffff0000, v17
  v_and_b32 v18, 0xffff0000, v18
  v_and_b32 v19, 0xffff0000, v19
  v_max3_f32 v40, v16, v17, v18
  v_max_f32 v40, v40, v19
  s_nop 1
  v_max_f32_dpp v40, v40, v40 row_ror:8 row_mask:0xf bank_mask:0xf
  s_nop 1
  v_max_f32_dpp v40, v40, v40 row_ror:4 row_mask:0xf bank_mask:0xf
  s_nop 1
  v_max_f32_dpp v40, v40, v40 row_ror:2 row_mask:0xf bank_mask:0xf
  s_nop 1
  v_max_f32_dpp v40, v40, v40 row_ror:1 row_mask:0xf bank_mask:0xf
  v_mov_b32 v32, v40
  s_nop 1
  v_permlane16_swap_b32 v40, v32
  v_max_f32 v40, v40, v32
  v_mov_b32 v32, v40
  s_nop 1
  v_permlane32_swap_b32 v40, v32
  v_max_f32 v40, v40, v32
  s_waitcnt vmcnt(2)
  buffer_load_dwordx4 v[68:71], v4, s[32:35], s70 offen offset:0 nt
  v_sub_f32 v16, v16, v40
  v_sub_f32 v17, v17, v40
  v_sub_f32 v18, v18, v40
  v_sub_f32 v19, v19, v40
  v_mul_f32 v16, 0x3fb8aa3b, v16
  v_mul_f32 v17, 0x3fb8aa3b, v17
  v_mul_f32 v18, 0x3fb8aa3b, v18
  v_mul_f32 v19, 0x3fb8aa3b, v19
  v_exp_f32 v16, v16
  v_exp_f32 v17, v17
  v_exp_f32 v18, v18
  v_exp_f32 v19, v19
  v_mul_f32 v40, 0x3fb8aa3b, v40
  v_add_f32 v41, v16, v17
  v_add_f32 v33, v18, v19
  v_add_f32 v41, v41, v33
  v_cvt_pk_bf16_f32 v16, v16, v16
  v_cvt_pk_bf16_f32 v17, v17, v17
  v_cvt_pk_bf16_f32 v18, v18, v18
  v_cvt_pk_bf16_f32 v19, v19, v19
  v_add_f32_dpp v41, v41, v41 row_ror:8 row_mask:0xf bank_mask:0xf
  s_nop 1
  v_add_f32_dpp v41, v41, v41 row_ror:4 row_mask:0xf bank_mask:0xf
  s_nop 1
  v_add_f32_dpp v41, v41, v41 row_ror:2 row_mask:0xf bank_mask:0xf
  s_nop 1
  v_add_f32_dpp v41, v41, v41 row_ror:1 row_mask:0xf bank_mask:0xf
  v_mov_b32 v32, v41
  s_nop 1
  v_permlane16_swap_b32 v41, v32
  v_add_f32 v41, v41, v32
  v_mov_b32 v32, v41
  s_nop 1
  v_permlane32_swap_b32 v41, v32
  v_add_f32 v41, v41, v32
  s_lshl_b32 s76, s64, 3
  v_mov_b32 v33, s76
  s_mov_b64 exec, 1
  ds_write_b64 v33, v[40:41] offset:256
  s_mov_b64 exec, -1
  v_and_b32_dpp v24, v16, v6 row_newbcast:0 row_mask:0xf bank_mask:0xf
  v_and_b32_dpp v25, v16, v7 row_newbcast:0 row_mask:0xf bank_mask:0xf
  v_and_b32_dpp v26, v16, v8 row_newbcast:0 row_mask:0xf bank_mask:0xf
  v_and_b32_dpp v27, v16, v9 row_newbcast:0 row_mask:0xf bank_mask:0xf
  s_waitcnt vmcnt(2)
  buffer_load_dwordx4 v[72:75], v4, s[32:35], s70 offen offset:1024 nt
  v_mfma_f32_16x16x32_bf16 v[20:23], v[24:27], v[52:55], 0
  v_and_b32_dpp v28, v16, v6 row_newbcast:8 row_mask:0xf bank_mask:0xf
  v_and_b32_dpp v29, v16, v7 row_newbcast:8 row_mask:0xf bank_mask:0xf
  v_and_b32_dpp v30, v16, v8 row_newbcast:8 row_mask:0xf bank_mask:0xf
  v_and_b32_dpp v31, v16, v9 row_newbcast:8 row_mask:0xf bank_mask:0xf
  s_nop 1
  v_mfma_f32_16x16x32_bf16 v[20:23], v[28:31], v[56:59], v[20:23]
  v_and_b32_dpp v24, v16, v6 row_newbcast:4 row_mask:0xf bank_mask:0xf
  v_and_b32_dpp v25, v16, v7 row_newbcast:4 row_mask:0xf bank_mask:0xf
  v_and_b32_dpp v26, v16, v8 row_newbcast:4 row_mask:0xf bank_mask:0xf
  v_and_b32_dpp v27, v16, v9 row_newbcast:4 row_mask:0xf bank_mask:0xf
  s_nop 1
  v_mfma_f32_16x16x32_bf16 v[20:23], v[24:27], v[60:63], v[20:23]
  v_and_b32_dpp v28, v16, v6 row_newbcast:12 row_mask:0xf bank_mask:0xf
  v_and_b32_dpp v29, v16, v7 row_newbcast:12 row_mask:0xf bank_mask:0xf
  v_and_b32_dpp v30, v16, v8 row_newbcast:12 row_mask:0xf bank_mask:0xf
  v_and_b32_dpp v31, v16, v9 row_newbcast:12 row_mask:0xf bank_mask:0xf
  s_waitcnt vmcnt(2)
  buffer_load_dwordx4 v[76:79], v4, s[32:35], s70 offen offset:2048 nt
  v_mfma_f32_16x16x32_bf16 v[20:23], v[28:31], v[64:67], v[20:23]
  v_and_b32_dpp v24, v16, v6 row_newbcast:1 row_mask:0xf bank_mask:0xf
  v_and_b32_dpp v25, v16, v7 row_newbcast:1 row_mask:0xf bank_mask:0xf
  v_and_b32_dpp v26, v16, v8 row_newbcast:1 row_mask:0xf bank_mask:0xf
  v_and_b32_dpp v27, v16, v9 row_newbcast:1 row_mask:0xf bank_mask:0xf
  s_waitcnt vmcnt(2)
  buffer_load_dwordx4 v[80:83], v4, s[32:35], s70 offen offset:3072 nt
  s_add_u32 s70, s70, 0x8000
  s_and_b32 s70, s70, 0x7ffff
  v_mfma_f32_16x16x32_bf16 v[20:23], v[24:27], v[68:71], v[20:23]
  v_and_b32_dpp v28, v16, v6 row_newbcast:9 row_mask:0xf bank_mask:0xf
  v_and_b32_dpp v29, v16, v7 row_newbcast:9 row_mask:0xf bank_mask:0xf
  v_and_b32_dpp v30, v16, v8 row_newbcast:9 row_mask:0xf bank_mask:0xf
  v_and_b32_dpp v31, v16, v9 row_newbcast:9 row_mask:0xf bank_mask:0xf
  s_waitcnt vmcnt(2)
  buffer_load_dwordx4 v[84:87], v4, s[32:35], s70 offen offset:0 nt
  v_mfma_f32_16x16x32_bf16 v[20:23], v[28:31], v[72:75], v[20:23]
  v_and_b32_dpp v24, v16, v6 row_newbcast:5 row_mask:0xf bank_mask:0xf
  v_and_b32_dpp v25, v16, v7 row_newbcast:5 row_mask:0xf bank_mask:0xf
  v_and_b32_dpp v26, v16, v8 row_newbcast:5 row_mask:0xf bank_mask:0xf
  v_and_b32_dpp v27, v16, v9 row_newbcast:5 row_mask:0xf bank_mask:0xf
  s_waitcnt vmcnt(2)
  buffer_load_dwordx4 v[88:91], v4, s[32:35], s70 offen offset:1024 nt
  v_mfma_f32_16x16x32_bf16 v[20:23], v[24:27], v[76:79], v[20:23]
  v_and_b32_dpp v28, v16, v6 row_newbcast:13 row_mask:0xf bank_mask:0xf
  v_and_b32_dpp v29, v16, v7 row_newbcast:13 row_mask:0xf bank_mask:0xf
  v_and_b32_dpp v30, v16, v8 row_newbcast:13 row_mask:0xf bank_mask:0xf
  v_and_b32_dpp v31, v16, v9 row_newbcast:13 row_mask:0xf bank_mask:0xf
  s_waitcnt vmcnt(2)
  buffer_load_dwordx4 v[92:95], v4, s[32:35], s70 offen offset:2048 nt
  v_mfma_f32_16x16x32_bf16 v[20:23], v[28:31], v[80:83], v[20:23]
  v_and_b32_dpp v24, v16, v6 row_newbcast:2 row_mask:0xf bank_mask:0xf
  v_and_b32_dpp v25, v16, v7 row_newbcast:2 row_mask:0xf bank_mask:0xf
  v_and_b32_dpp v26, v16, v8 row_newbcast:2 row_mask:0xf bank_mask:0xf
  v_and_b32_dpp v27, v16, v9 row_newbcast:2 row_mask:0xf bank_mask:0xf
  s_waitcnt vmcnt(2)
  buffer_load_dwordx4 v[96:99], v4, s[32:35], s70 offen offset:3072 nt
  s_add_u32 s70, s70, 0x8000
  s_and_b32 s70, s70, 0x7ffff
  v_mfma_f32_16x16x32_bf16 v[20:23], v[24:27], v[84:87], v[20:23]
  v_and_b32_dpp v28, v16, v6 row_newbcast:10 row_mask:0xf bank_mask:0xf
  v_and_b32_dpp v29, v16, v7 row_newbcast:10 row_mask:0xf bank_mask:0xf
  v_and_b32_dpp v30, v16, v8 row_newbcast:10 row_mask:0xf bank_mask:0xf
  v_and_b32_dpp v31, v16, v9 row_newbcast:10 row_mask:0xf bank_mask:0xf
  s_waitcnt vmcnt(2)
  buffer_load_dwordx4 v[100:103], v4, s[32:35], s70 offen offset:0 nt
  v_mfma_f32_16x16x32_bf16 v[20:23], v[28:31], v[88:91], v[20:23]
  v_and_b32_dpp v24, v16, v6 row_newbcast:6 row_mask:0xf bank_mask:0xf
  v_and_b32_dpp v25, v16, v7 row_newbcast:6 row_mask:0xf bank_mask:0xf
  v_and_b32_dpp v26, v16, v8 row_newbcast:6 row_mask:0xf bank_mask:0xf
  v_and_b32_dpp v27, v16, v9 row_newbcast:6 row_mask:0xf bank_mask:0xf
  s_waitcnt vmcnt(2)
  buffer_load_dwordx4 v[104:107], v4, s[32:35], s70 offen offset:1024 nt
  v_mfma_f32_16x16x32_bf16 v[20:23], v[24:27], v[92:95], v[20:23]
  v_and_b32_dpp v28, v16, v6 row_newbcast:14 row_mask:0xf bank_mask:0xf
  v_and_b32_dpp v29, v16, v7 row_newbcast:14 row_mask:0xf bank_mask:0xf
  v_and_b32_dpp v30, v16, v8 row_newbcast:14 row_mask:0xf bank_mask:0xf
  v_and_b32_dpp v31, v16, v9 row_newbcast:14 row_mask:0xf bank_mask:0xf
  s_waitcnt vmcnt(2)
  buffer_load_dwordx4 v[108:111], v4, s[32:35], s70 offen offset:2048 nt
  v_mfma_f32_16x16x32_bf16 v[20:23], v[28:31], v[96:99], v[20:23]
  v_and_b32_dpp v24, v16, v6 row_newbcast:3 row_mask:0xf bank_mask:0xf
  v_and_b32_dpp v25, v16, v7 row_newbcast:3 row_mask:0xf bank_mask:0xf
  v_and_b32_dpp v26, v16, v8 row_newbcast:3 row_mask:0xf bank_mask:0xf
  v_and_b32_dpp v27, v16, v9 row_newbcast:3 row_mask:0xf bank_mask:0xf
  s_waitcnt vmcnt(2)
  buffer_load_dwordx4 v[112:115], v4, s[32:35], s70 offen offset:3072 nt
  s_add_u32 s70, s70, 0x8000
  s_and_b32 s70, s70, 0x7ffff
  v_mfma_f32_16x16x32_bf16 v[20:23], v[24:27], v[100:103], v[20:23]
  v_and_b32_dpp v28, v16, v6 row_newbcast:11 row_mask:0xf bank_mask:0xf
  v_and_b32_dpp v29, v16, v7 row_newbcast:11 row_mask:0xf bank_mask:0xf
  v_and_b32_dpp v30, v16, v8 row_newbcast:11 row_mask:0xf bank_mask:0xf
  v_and_b32_dpp v31, v16, v9 row_newbcast:11 row_mask:0xf bank_mask:0xf
  s_waitcnt vmcnt(2)
  buffer_load_dwordx4 v[116:119], v4, s[32:35], s70 offen offset:0 nt
  v_mfma_f32_16x16x32_bf16 v[20:23], v[28:31], v[104:107], v[20:23]
  v_and_b32_dpp v24, v16, v6 row_newbcast:7 row_mask:0xf bank_mask:0xf
  v_and_b32_dpp v25, v16, v7 row_newbcast:7 row_mask:0xf bank_mask:0xf
  v_and_b32_dpp v26, v16, v8 row_newbcast:7 row_mask:0xf bank_mask:0xf
  v_and_b32_dpp v27, v16, v9 row_newbcast:7 row_mask:0xf bank_mask:0xf
  s_waitcnt vmcnt(2)
  buffer_load_dwordx4 v[120:123], v4, s[32:35], s70 offen offset:1024 nt
  v_mfma_f32_16x16x32_bf16 v[20:23], v[24:27], v[108:111], v[20:23]
  v_and_b32_dpp v28, v16, v6 row_newbcast:15 row_mask:0xf bank_mask:0xf
  v_and_b32_dpp v29, v16, v7 row_newbcast:15 row_mask:0xf bank_mask:0xf
  v_and_b32_dpp v30, v16, v8 row_newbcast:15 row_mask:0xf bank_mask:0xf
  v_and_b32_dpp v31, v16, v9 row_newbcast:15 row_mask:0xf bank_mask:0xf
  s_waitcnt vmcnt(2)
  buffer_load_dwordx4 v[124:127], v4, s[32:35], s70 offen offset:2048 nt
  v_mfma_f32_16x16x32_bf16 v[20:23], v[28:31], v[112:115], v[20:23]
  v_and_b32_dpp v24, v17, v6 row_newbcast:0 row_mask:0xf bank_mask:0xf
  v_and_b32_dpp v25, v17, v7 row_newbcast:0 row_mask:0xf bank_mask:0xf
  v_and_b32_dpp v26, v17, v8 row_newbcast:0 row_mask:0xf bank_mask:0xf
  v_and_b32_dpp v27, v17, v9 row_newbcast:0 row_mask:0xf bank_mask:0xf
  s_waitcnt vmcnt(2)
  buffer_load_dwordx4 v[128:131], v4, s[32:35], s70 offen offset:3072 nt
  s_add_u32 s70, s70, 0x8000
  s_and_b32 s70, s70, 0x7ffff
  v_mfma_f32_16x16x32_bf16 v[20:23], v[24:27], v[116:119], v[20:23]
  v_and_b32_dpp v28, v17, v6 row_newbcast:8 row_mask:0xf bank_mask:0xf
  v_and_b32_dpp v29, v17, v7 row_newbcast:8 row_mask:0xf bank_mask:0xf
  v_and_b32_dpp v30, v17, v8 row_newbcast:8 row_mask:0xf bank_mask:0xf
  v_and_b32_dpp v31, v17, v9 row_newbcast:8 row_mask:0xf bank_mask:0xf
  s_waitcnt vmcnt(2)
  buffer_load_dwordx4 v[132:135], v4, s[32:35], s70 offen offset:0 nt
  v_mfma_f32_16x16x32_bf16 v[20:23], v[28:31], v[120:123], v[20:23]
  v_and_b32_dpp v24, v17, v6 row_newbcast:4 row_mask:0xf bank_mask:0xf
  v_and_b32_dpp v25, v17, v7 row_newbcast:4 row_mask:0xf bank_mask:0xf
  v_and_b32_dpp v26, v17, v8 row_newbcast:4 row_mask:0xf bank_mask:0xf
  v_and_b32_dpp v27, v17, v9 row_newbcast:4 row_mask:0xf bank_mask:0xf
  s_waitcnt vmcnt(2)
  buffer_load_dwordx4 v[136:139], v4, s[32:35], s70 offen offset:1024 nt
  v_mfma_f32_16x16x32_bf16 v[20:23], v[24:27], v[124:127], v[20:23]
  v_and_b32_dpp v28, v17, v6 row_newbcast:12 row_mask:0xf bank_mask:0xf
  v_and_b32_dpp v29, v17, v7 row_newbcast:12 row_mask:0xf bank_mask:0xf
  v_and_b32_dpp v30, v17, v8 row_newbcast:12 row_mask:0xf bank_mask:0xf
  v_and_b32_dpp v31, v17, v9 row_newbcast:12 row_mask:0xf bank_mask:0xf
  s_waitcnt vmcnt(2)
  buffer_load_dwordx4 v[140:143], v4, s[32:35], s70 offen offset:2048 nt
  v_mfma_f32_16x16x32_bf16 v[20:23], v[28:31], v[128:131], v[20:23]
  v_and_b32_dpp v24, v17, v6 row_newbcast:1 row_mask:0xf bank_mask:0xf
  v_and_b32_dpp v25, v17, v7 row_newbcast:1 row_mask:0xf bank_mask:0xf
  v_and_b32_dpp v26, v17, v8 row_newbcast:1 row_mask:0xf bank_mask:0xf
  v_and_b32_dpp v27, v17, v9 row_newbcast:1 row_mask:0xf bank_mask:0xf
  s_waitcnt vmcnt(2)
  buffer_load_dwordx4 v[144:147], v4, s[32:35], s70 offen offset:3072 nt
  s_add_u32 s70, s70, 0x8000
  s_and_b32 s70, s70, 0x7ffff
  v_mfma_f32_16x16x32_bf16 v[20:23], v[24:27], v[132:135], v[20:23]
  v_and_b32_dpp v28, v17, v6 row_newbcast:9 row_mask:0xf bank_mask:0xf
  v_and_b32_dpp v29, v17, v7 row_newbcast:9 row_mask:0xf bank_mask:0xf
  v_and_b32_dpp v30, v17, v8 row_newbcast:9 row_mask:0xf bank_mask:0xf
  v_and_b32_dpp v31, v17, v9 row_newbcast:9 row_mask:0xf bank_mask:0xf
  s_waitcnt vmcnt(2)
  buffer_load_dwordx4 v[148:151], v4, s[32:35], s70 offen offset:0 nt
  v_mfma_f32_16x16x32_bf16 v[20:23], v[28:31], v[136:139], v[20:23]
  v_and_b32_dpp v24, v17, v6 row_newbcast:5 row_mask:0xf bank_mask:0xf
  v_and_b32_dpp v25, v17, v7 row_newbcast:5 row_mask:0xf bank_mask:0xf
  v_and_b32_dpp v26, v17, v8 row_newbcast:5 row_mask:0xf bank_mask:0xf
  v_and_b32_dpp v27, v17, v9 row_newbcast:5 row_mask:0xf bank_mask:0xf
  s_waitcnt vmcnt(2)
  buffer_load_dwordx4 v[152:155], v4, s[32:35], s70 offen offset:1024 nt
  v_mfma_f32_16x16x32_bf16 v[20:23], v[24:27], v[140:143], v[20:23]
  v_and_b32_dpp v28, v17, v6 row_newbcast:13 row_mask:0xf bank_mask:0xf
  v_and_b32_dpp v29, v17, v7 row_newbcast:13 row_mask:0xf bank_mask:0xf
  v_and_b32_dpp v30, v17, v8 row_newbcast:13 row_mask:0xf bank_mask:0xf
  v_and_b32_dpp v31, v17, v9 row_newbcast:13 row_mask:0xf bank_mask:0xf
  s_waitcnt vmcnt(2)
  buffer_load_dwordx4 v[156:159], v4, s[32:35], s70 offen offset:2048 nt
  v_mfma_f32_16x16x32_bf16 v[20:23], v[28:31], v[144:147], v[20:23]
  v_and_b32_dpp v24, v17, v6 row_newbcast:2 row_mask:0xf bank_mask:0xf
  v_and_b32_dpp v25, v17, v7 row_newbcast:2 row_mask:0xf bank_mask:0xf
  v_and_b32_dpp v26, v17, v8 row_newbcast:2 row_mask:0xf bank_mask:0xf
  v_and_b32_dpp v27, v17, v9 row_newbcast:2 row_mask:0xf bank_mask:0xf
  s_waitcnt vmcnt(2)
  buffer_load_dwordx4 v[160:163], v4, s[32:35], s70 offen offset:3072 nt
  s_add_u32 s70, s70, 0x8000
  s_and_b32 s70, s70, 0x7ffff
  v_mfma_f32_16x16x32_bf16 v[20:23], v[24:27], v[148:151], v[20:23]
  v_and_b32_dpp v28, v17, v6 row_newbcast:10 row_mask:0xf bank_mask:0xf
  v_and_b32_dpp v29, v17, v7 row_newbcast:10 row_mask:0xf bank_mask:0xf
  v_and_b32_dpp v30, v17, v8 row_newbcast:10 row_mask:0xf bank_mask:0xf
  v_and_b32_dpp v31, v17, v9 row_newbcast:10 row_mask:0xf bank_mask:0xf
  s_waitcnt vmcnt(2)
  buffer_load_dwordx4 v[164:167], v4, s[32:35], s70 offen offset:0 nt
  v_mfma_f32_16x16x32_bf16 v[20:23], v[28:31], v[152:155], v[20:23]
  v_and_b32_dpp v24, v17, v6 row_newbcast:6 row_mask:0xf bank_mask:0xf
  v_and_b32_dpp v25, v17, v7 row_newbcast:6 row_mask:0xf bank_mask:0xf
  v_and_b32_dpp v26, v17, v8 row_newbcast:6 row_mask:0xf bank_mask:0xf
  v_and_b32_dpp v27, v17, v9 row_newbcast:6 row_mask:0xf bank_mask:0xf
  s_waitcnt vmcnt(2)
  buffer_load_dwordx4 v[44:47], v4, s[32:35], s70 offen offset:1024 nt
  v_mfma_f32_16x16x32_bf16 v[20:23], v[24:27], v[156:159], v[20:23]
  v_and_b32_dpp v28, v17, v6 row_newbcast:14 row_mask:0xf bank_mask:0xf
  v_and_b32_dpp v29, v17, v7 row_newbcast:14 row_mask:0xf bank_mask:0xf
  v_and_b32_dpp v30, v17, v8 row_newbcast:14 row_mask:0xf bank_mask:0xf
  v_and_b32_dpp v31, v17, v9 row_newbcast:14 row_mask:0xf bank_mask:0xf
  v_mov_b32 v11, 256
  s_mov_b64 exec, 1
  ds_add_u32 v5, v11 offset:364
  s_mov_b64 exec, -1
  s_waitcnt vmcnt(2)
  buffer_load_dwordx4 v[48:51], v4, s[32:35], s70 offen offset:2048 nt
  v_mfma_f32_16x16x32_bf16 v[20:23], v[28:31], v[160:163], v[20:23]
  v_and_b32_dpp v24, v17, v6 row_newbcast:3 row_mask:0xf bank_mask:0xf
  v_and_b32_dpp v25, v17, v7 row_newbcast:3 row_mask:0xf bank_mask:0xf
  v_and_b32_dpp v26, v17, v8 row_newbcast:3 row_mask:0xf bank_mask:0xf
  v_and_b32_dpp v27, v17, v9 row_newbcast:3 row_mask:0xf bank_mask:0xf
  s_waitcnt vmcnt(2)
  buffer_load_dwordx4 v[52:55], v4, s[32:35], s70 offen offset:3072 nt
  s_add_u32 s70, s70, 0x8000
  s_and_b32 s70, s70, 0x7ffff
  v_mfma_f32_16x16x32_bf16 v[20:23], v[24:27], v[164:167], v[20:23]
  v_and_b32_dpp v28, v17, v6 row_newbcast:11 row_mask:0xf bank_mask:0xf
  v_and_b32_dpp v29, v17, v7 row_newbcast:11 row_mask:0xf bank_mask:0xf
  v_and_b32_dpp v30, v17, v8 row_newbcast:11 row_mask:0xf bank_mask:0xf
  v_and_b32_dpp v31, v17, v9 row_newbcast:11 row_mask:0xf bank_mask:0xf
  s_waitcnt vmcnt(2)
  buffer_load_dwordx4 v[56:59], v4, s[32:35], s70 offen offset:0 nt
  v_mfma_f32_16x16x32_bf16 v[20:23], v[28:31], v[44:47], v[20:23]
  v_and_b32_dpp v24, v17, v6 row_newbcast:7 row_mask:0xf bank_mask:0xf
  v_and_b32_dpp v25, v17, v7 row_newbcast:7 row_mask:0xf bank_mask:0xf
  v_and_b32_dpp v26, v17, v8 row_newbcast:7 row_mask:0xf bank_mask:0xf
  v_and_b32_dpp v27, v17, v9 row_newbcast:7 row_mask:0xf bank_mask:0xf
  s_waitcnt vmcnt(2)
  buffer_load_dwordx4 v[60:63], v4, s[32:35], s70 offen offset:1024 nt
  v_mfma_f32_16x16x32_bf16 v[20:23], v[24:27], v[48:51], v[20:23]
  v_and_b32_dpp v28, v17, v6 row_newbcast:15 row_mask:0xf bank_mask:0xf
  v_and_b32_dpp v29, v17, v7 row_newbcast:15 row_mask:0xf bank_mask:0xf
  v_and_b32_dpp v30, v17, v8 row_newbcast:15 row_mask:0xf bank_mask:0xf
  v_and_b32_dpp v31, v17, v9 row_newbcast:15 row_mask:0xf bank_mask:0xf
  s_waitcnt vmcnt(2)
  buffer_load_dwordx4 v[64:67], v4, s[32:35], s70 offen offset:2048 nt
  v_mfma_f32_16x16x32_bf16 v[20:23], v[28:31], v[52:55], v[20:23]
  v_and_b32_dpp v24, v18, v6 row_newbcast:0 row_mask:0xf bank_mask:0xf
  v_and_b32_dpp v25, v18, v7 row_newbcast:0 row_mask:0xf bank_mask:0xf
  v_and_b32_dpp v26, v18, v8 row_newbcast:0 row_mask:0xf bank_mask:0xf
  v_and_b32_dpp v27, v18, v9 row_newbcast:0 row_mask:0xf bank_mask:0xf
  s_waitcnt vmcnt(2)
  buffer_load_dwordx4 v[68:71], v4, s[32:35], s70 offen offset:3072 nt
  s_add_u32 s70, s70, 0x8000
  s_and_b32 s70, s70, 0x7ffff
  v_mfma_f32_16x16x32_bf16 v[20:23], v[24:27], v[56:59], v[20:23]
  v_and_b32_dpp v28, v18, v6 row_newbcast:8 row_mask:0xf bank_mask:0xf
  v_and_b32_dpp v29, v18, v7 row_newbcast:8 row_mask:0xf bank_mask:0xf
  v_and_b32_dpp v30, v18, v8 row_newbcast:8 row_mask:0xf bank_mask:0xf
  v_and_b32_dpp v31, v18, v9 row_newbcast:8 row_mask:0xf bank_mask:0xf
  s_waitcnt vmcnt(2)
  buffer_load_dwordx4 v[72:75], v4, s[32:35], s70 offen offset:0 nt
  v_mfma_f32_16x16x32_bf16 v[20:23], v[28:31], v[60:63], v[20:23]
  v_and_b32_dpp v24, v18, v6 row_newbcast:4 row_mask:0xf bank_mask:0xf
  v_and_b32_dpp v25, v18, v7 row_newbcast:4 row_mask:0xf bank_mask:0xf
  v_and_b32_dpp v26, v18, v8 row_newbcast:4 row_mask:0xf bank_mask:0xf
  v_and_b32_dpp v27, v18, v9 row_newbcast:4 row_mask:0xf bank_mask:0xf
  s_waitcnt vmcnt(2)
  buffer_load_dwordx4 v[76:79], v4, s[32:35], s70 offen offset:1024 nt
  v_mfma_f32_16x16x32_bf16 v[20:23], v[24:27], v[64:67], v[20:23]
  v_and_b32_dpp v28, v18, v6 row_newbcast:12 row_mask:0xf bank_mask:0xf
  v_and_b32_dpp v29, v18, v7 row_newbcast:12 row_mask:0xf bank_mask:0xf
  v_and_b32_dpp v30, v18, v8 row_newbcast:12 row_mask:0xf bank_mask:0xf
  v_and_b32_dpp v31, v18, v9 row_newbcast:12 row_mask:0xf bank_mask:0xf
  s_waitcnt vmcnt(2)
  buffer_load_dwordx4 v[80:83], v4, s[32:35], s70 offen offset:2048 nt
  v_mfma_f32_16x16x32_bf16 v[20:23], v[28:31], v[68:71], v[20:23]
  v_and_b32_dpp v24, v18, v6 row_newbcast:1 row_mask:0xf bank_mask:0xf
  v_and_b32_dpp v25, v18, v7 row_newbcast:1 row_mask:0xf bank_mask:0xf
  v_and_b32_dpp v26, v18, v8 row_newbcast:1 row_mask:0xf bank_mask:0xf
  v_and_b32_dpp v27, v18, v9 row_newbcast:1 row_mask:0xf bank_mask:0xf
  s_waitcnt vmcnt(2)
  buffer_load_dwordx4 v[84:87], v4, s[32:35], s70 offen offset:3072 nt
  s_add_u32 s70, s70, 0x8000
  s_and_b32 s70, s70, 0x7ffff
  v_mfma_f32_16x16x32_bf16 v[20:23], v[24:27], v[72:75], v[20:23]
  v_and_b32_dpp v28, v18, v6 row_newbcast:9 row_mask:0xf bank_mask:0xf
  v_and_b32_dpp v29, v18, v7 row_newbcast:9 row_mask:0xf bank_mask:0xf
  v_and_b32_dpp v30, v18, v8 row_newbcast:9 row_mask:0xf bank_mask:0xf
  v_and_b32_dpp v31, v18, v9 row_newbcast:9 row_mask:0xf bank_mask:0xf
  s_waitcnt vmcnt(2)
  buffer_load_dwordx4 v[88:91], v4, s[32:35], s70 offen offset:0 nt
  v_mfma_f32_16x16x32_bf16 v[20:23], v[28:31], v[76:79], v[20:23]
  v_and_b32_dpp v24, v18, v6 row_newbcast:5 row_mask:0xf bank_mask:0xf
  v_and_b32_dpp v25, v18, v7 row_newbcast:5 row_mask:0xf bank_mask:0xf
  v_and_b32_dpp v26, v18, v8 row_newbcast:5 row_mask:0xf bank_mask:0xf
  v_and_b32_dpp v27, v18, v9 row_newbcast:5 row_mask:0xf bank_mask:0xf
  s_waitcnt vmcnt(2)
  buffer_load_dwordx4 v[92:95], v4, s[32:35], s70 offen offset:1024 nt
  v_mfma_f32_16x16x32_bf16 v[20:23], v[24:27], v[80:83], v[20:23]
  v_and_b32_dpp v28, v18, v6 row_newbcast:13 row_mask:0xf bank_mask:0xf
  v_and_b32_dpp v29, v18, v7 row_newbcast:13 row_mask:0xf bank_mask:0xf
  v_and_b32_dpp v30, v18, v8 row_newbcast:13 row_mask:0xf bank_mask:0xf
  v_and_b32_dpp v31, v18, v9 row_newbcast:13 row_mask:0xf bank_mask:0xf
  s_waitcnt vmcnt(2)
  buffer_load_dwordx4 v[96:99], v4, s[32:35], s70 offen offset:2048 nt
  v_mfma_f32_16x16x32_bf16 v[20:23], v[28:31], v[84:87], v[20:23]
  v_and_b32_dpp v24, v18, v6 row_newbcast:2 row_mask:0xf bank_mask:0xf
  v_and_b32_dpp v25, v18, v7 row_newbcast:2 row_mask:0xf bank_mask:0xf
  v_and_b32_dpp v26, v18, v8 row_newbcast:2 row_mask:0xf bank_mask:0xf
  v_and_b32_dpp v27, v18, v9 row_newbcast:2 row_mask:0xf bank_mask:0xf
  s_waitcnt vmcnt(2)
  buffer_load_dwordx4 v[100:103], v4, s[32:35], s70 offen offset:3072 nt
  s_add_u32 s70, s70, 0x8000
  s_and_b32 s70, s70, 0x7ffff
  v_mfma_f32_16x16x32_bf16 v[20:23], v[24:27], v[88:91], v[20:23]
  v_and_b32_dpp v28, v18, v6 row_newbcast:10 row_mask:0xf bank_mask:0xf
  v_and_b32_dpp v29, v18, v7 row_newbcast:10 row_mask:0xf bank_mask:0xf
  v_and_b32_dpp v30, v18, v8 row_newbcast:10 row_mask:0xf bank_mask:0xf
  v_and_b32_dpp v31, v18, v9 row_newbcast:10 row_mask:0xf bank_mask:0xf
  v_lshlrev_b32 v36, 5, v3
  v_lshl_add_u32 v36, v2, 4, v36
  s_lshl_b32 s76, s64, 9
  v_add_u32 v36, s76, v36
  v_and_b32 v37, 31, v1
  v_lshrrev_b32 v32, 5, v1
  v_lshlrev_b32 v38, 3, v37
  v_lshl_add_u32 v38, v32, 2, v38
  v_lshlrev_b32 v37, 4, v37
  v_lshl_add_u32 v37, v32, 11, v37
  s_lshl_b32 s73, s65, 8
  s_add_u32 s73, s73, 65536
  s_lshl_b32 s76, s64, 2
  v_mov_b32 v39, s76
  s_waitcnt vmcnt(2)
  buffer_load_dwordx4 v[104:107], v4, s[32:35], s70 offen offset:0 nt
  v_mfma_f32_16x16x32_bf16 v[20:23], v[28:31], v[92:95], v[20:23]
  v_and_b32_dpp v24, v18, v6 row_newbcast:6 row_mask:0xf bank_mask:0xf
  v_and_b32_dpp v25, v18, v7 row_newbcast:6 row_mask:0xf bank_mask:0xf
  v_and_b32_dpp v26, v18, v8 row_newbcast:6 row_mask:0xf bank_mask:0xf
  v_and_b32_dpp v27, v18, v9 row_newbcast:6 row_mask:0xf bank_mask:0xf
  s_waitcnt vmcnt(2)
  buffer_load_dwordx4 v[108:111], v4, s[32:35], s70 offen offset:1024 nt
  v_mfma_f32_16x16x32_bf16 v[20:23], v[24:27], v[96:99], v[20:23]
  v_and_b32_dpp v28, v18, v6 row_newbcast:14 row_mask:0xf bank_mask:0xf
  v_and_b32_dpp v29, v18, v7 row_newbcast:14 row_mask:0xf bank_mask:0xf
  v_and_b32_dpp v30, v18, v8 row_newbcast:14 row_mask:0xf bank_mask:0xf
  v_and_b32_dpp v31, v18, v9 row_newbcast:14 row_mask:0xf bank_mask:0xf
  s_waitcnt vmcnt(2)
  buffer_load_dwordx4 v[112:115], v4, s[32:35], s70 offen offset:2048 nt
  v_mfma_f32_16x16x32_bf16 v[20:23], v[28:31], v[100:103], v[20:23]
  v_and_b32_dpp v24, v18, v6 row_newbcast:3 row_mask:0xf bank_mask:0xf
  v_and_b32_dpp v25, v18, v7 row_newbcast:3 row_mask:0xf bank_mask:0xf
  v_and_b32_dpp v26, v18, v8 row_newbcast:3 row_mask:0xf bank_mask:0xf
  v_and_b32_dpp v27, v18, v9 row_newbcast:3 row_mask:0xf bank_mask:0xf
  s_waitcnt vmcnt(2)
  buffer_load_dwordx4 v[116:119], v4, s[32:35], s70 offen offset:3072 nt
  s_add_u32 s70, s70, 0x8000
  s_and_b32 s70, s70, 0x7ffff
  v_mfma_f32_16x16x32_bf16 v[20:23], v[24:27], v[104:107], v[20:23]
  v_and_b32_dpp v28, v18, v6 row_newbcast:11 row_mask:0xf bank_mask:0xf
  v_and_b32_dpp v29, v18, v7 row_newbcast:11 row_mask:0xf bank_mask:0xf
  v_and_b32_dpp v30, v18, v8 row_newbcast:11 row_mask:0xf bank_mask:0xf
  v_and_b32_dpp v31, v18, v9 row_newbcast:11 row_mask:0xf bank_mask:0xf
  s_waitcnt vmcnt(2)
  buffer_load_dwordx4 v[120:123], v4, s[32:35], s70 offen offset:0 nt
  v_mfma_f32_16x16x32_bf16 v[20:23], v[28:31], v[108:111], v[20:23]
  v_and_b32_dpp v24, v18, v6 row_newbcast:7 row_mask:0xf bank_mask:0xf
  v_and_b32_dpp v25, v18, v7 row_newbcast:7 row_mask:0xf bank_mask:0xf
  v_and_b32_dpp v26, v18, v8 row_newbcast:7 row_mask:0xf bank_mask:0xf
  v_and_b32_dpp v27, v18, v9 row_newbcast:7 row_mask:0xf bank_mask:0xf
  s_waitcnt vmcnt(2)
  buffer_load_dwordx4 v[124:127], v4, s[32:35], s70 offen offset:1024 nt
  v_mfma_f32_16x16x32_bf16 v[20:23], v[24:27], v[112:115], v[20:23]
  v_and_b32_dpp v28, v18, v6 row_newbcast:15 row_mask:0xf bank_mask:0xf
  v_and_b32_dpp v29, v18, v7 row_newbcast:15 row_mask:0xf bank_mask:0xf
  v_and_b32_dpp v30, v18, v8 row_newbcast:15 row_mask:0xf bank_mask:0xf
  v_and_b32_dpp v31, v18, v9 row_newbcast:15 row_mask:0xf bank_mask:0xf
  s_waitcnt vmcnt(2)
  buffer_load_dwordx4 v[128:131], v4, s[32:35], s70 offen offset:2048 nt
  v_mfma_f32_16x16x32_bf16 v[20:23], v[28:31], v[116:119], v[20:23]
  v_and_b32_dpp v24, v19, v6 row_newbcast:0 row_mask:0xf bank_mask:0xf
  v_and_b32_dpp v25, v19, v7 row_newbcast:0 row_mask:0xf bank_mask:0xf
  v_and_b32_dpp v26, v19, v8 row_newbcast:0 row_mask:0xf bank_mask:0xf
  v_and_b32_dpp v27, v19, v9 row_newbcast:0 row_mask:0xf bank_mask:0xf
  s_waitcnt vmcnt(2)
  buffer_load_dwordx4 v[132:135], v4, s[32:35], s70 offen offset:3072 nt
  s_add_u32 s70, s70, 0x8000
  s_and_b32 s70, s70, 0x7ffff
  v_mfma_f32_16x16x32_bf16 v[20:23], v[24:27], v[120:123], v[20:23]
  v_and_b32_dpp v28, v19, v6 row_newbcast:8 row_mask:0xf bank_mask:0xf
  v_and_b32_dpp v29, v19, v7 row_newbcast:8 row_mask:0xf bank_mask:0xf
  v_and_b32_dpp v30, v19, v8 row_newbcast:8 row_mask:0xf bank_mask:0xf
  v_and_b32_dpp v31, v19, v9 row_newbcast:8 row_mask:0xf bank_mask:0xf
  s_waitcnt vmcnt(2)
  buffer_load_dwordx4 v[136:139], v4, s[32:35], s70 offen offset:0 nt
  v_mfma_f32_16x16x32_bf16 v[20:23], v[28:31], v[124:127], v[20:23]
  v_and_b32_dpp v24, v19, v6 row_newbcast:4 row_mask:0xf bank_mask:0xf
  v_and_b32_dpp v25, v19, v7 row_newbcast:4 row_mask:0xf bank_mask:0xf
  v_and_b32_dpp v26, v19, v8 row_newbcast:4 row_mask:0xf bank_mask:0xf
  v_and_b32_dpp v27, v19, v9 row_newbcast:4 row_mask:0xf bank_mask:0xf
  s_waitcnt vmcnt(2)
  buffer_load_dwordx4 v[140:143], v4, s[32:35], s70 offen offset:1024 nt
  v_mfma_f32_16x16x32_bf16 v[20:23], v[24:27], v[128:131], v[20:23]
  v_and_b32_dpp v28, v19, v6 row_newbcast:12 row_mask:0xf bank_mask:0xf
  v_and_b32_dpp v29, v19, v7 row_newbcast:12 row_mask:0xf bank_mask:0xf
  v_and_b32_dpp v30, v19, v8 row_newbcast:12 row_mask:0xf bank_mask:0xf
  v_and_b32_dpp v31, v19, v9 row_newbcast:12 row_mask:0xf bank_mask:0xf
  s_waitcnt vmcnt(2)
  buffer_load_dwordx4 v[144:147], v4, s[32:35], s70 offen offset:2048 nt
  v_mfma_f32_16x16x32_bf16 v[20:23], v[28:31], v[132:135], v[20:23]
  v_and_b32_dpp v24, v19, v6 row_newbcast:1 row_mask:0xf bank_mask:0xf
  v_and_b32_dpp v25, v19, v7 row_newbcast:1 row_mask:0xf bank_mask:0xf
  v_and_b32_dpp v26, v19, v8 row_newbcast:1 row_mask:0xf bank_mask:0xf
  v_and_b32_dpp v27, v19, v9 row_newbcast:1 row_mask:0xf bank_mask:0xf
  s_waitcnt vmcnt(2)
  buffer_load_dwordx4 v[148:151], v4, s[32:35], s70 offen offset:3072 nt
  s_add_u32 s70, s70, 0x8000
  s_and_b32 s70, s70, 0x7ffff
  v_mfma_f32_16x16x32_bf16 v[20:23], v[24:27], v[136:139], v[20:23]
  v_and_b32_dpp v28, v19, v6 row_newbcast:9 row_mask:0xf bank_mask:0xf
  v_and_b32_dpp v29, v19, v7 row_newbcast:9 row_mask:0xf bank_mask:0xf
  v_and_b32_dpp v30, v19, v8 row_newbcast:9 row_mask:0xf bank_mask:0xf
  v_and_b32_dpp v31, v19, v9 row_newbcast:9 row_mask:0xf bank_mask:0xf
  v_mov_b32 v11, 65536
  s_mov_b64 exec, 1
  ds_add_u32 v5, v11 offset:364
  s_mov_b64 exec, -1
  s_waitcnt vmcnt(2)
  buffer_load_dwordx4 v[152:155], v4, s[32:35], s70 offen offset:0 nt
  v_mfma_f32_16x16x32_bf16 v[20:23], v[28:31], v[140:143], v[20:23]
  v_and_b32_dpp v24, v19, v6 row_newbcast:5 row_mask:0xf bank_mask:0xf
  v_and_b32_dpp v25, v19, v7 row_newbcast:5 row_mask:0xf bank_mask:0xf
  v_and_b32_dpp v26, v19, v8 row_newbcast:5 row_mask:0xf bank_mask:0xf
  v_and_b32_dpp v27, v19, v9 row_newbcast:5 row_mask:0xf bank_mask:0xf
  s_waitcnt vmcnt(2)
  buffer_load_dwordx4 v[156:159], v4, s[32:35], s70 offen offset:1024 nt
  v_mfma_f32_16x16x32_bf16 v[20:23], v[24:27], v[144:147], v[20:23]
  v_and_b32_dpp v28, v19, v6 row_newbcast:13 row_mask:0xf bank_mask:0xf
  v_and_b32_dpp v29, v19, v7 row_newbcast:13 row_mask:0xf bank_mask:0xf
  v_and_b32_dpp v30, v19, v8 row_newbcast:13 row_mask:0xf bank_mask:0xf
  v_and_b32_dpp v31, v19, v9 row_newbcast:13 row_mask:0xf bank_mask:0xf
  s_waitcnt vmcnt(2)
  buffer_load_dwordx4 v[160:163], v4, s[32:35], s70 offen offset:2048 nt
  v_mfma_f32_16x16x32_bf16 v[20:23], v[28:31], v[148:151], v[20:23]
  v_and_b32_dpp v24, v19, v6 row_newbcast:2 row_mask:0xf bank_mask:0xf
  v_and_b32_dpp v25, v19, v7 row_newbcast:2 row_mask:0xf bank_mask:0xf
  v_and_b32_dpp v26, v19, v8 row_newbcast:2 row_mask:0xf bank_mask:0xf
  v_and_b32_dpp v27, v19, v9 row_newbcast:2 row_mask:0xf bank_mask:0xf
  s_waitcnt vmcnt(2)
  buffer_load_dwordx4 v[164:167], v4, s[32:35], s70 offen offset:3072 nt
  s_add_u32 s70, s70, 0x8000
  s_and_b32 s70, s70, 0x7ffff
  v_mfma_f32_16x16x32_bf16 v[20:23], v[24:27], v[152:155], v[20:23]
  v_and_b32_dpp v28, v19, v6 row_newbcast:10 row_mask:0xf bank_mask:0xf
  v_and_b32_dpp v29, v19, v7 row_newbcast:10 row_mask:0xf bank_mask:0xf
  v_and_b32_dpp v30, v19, v8 row_newbcast:10 row_mask:0xf bank_mask:0xf
  v_and_b32_dpp v31, v19, v9 row_newbcast:10 row_mask:0xf bank_mask:0xf
  s_waitcnt vmcnt(2)
  buffer_load_dwordx4 v[44:47], v4, s[32:35], s70 offen offset:0 nt
  v_mfma_f32_16x16x32_bf16 v[20:23], v[28:31], v[156:159], v[20:23]
  v_and_b32_dpp v24, v19, v6 row_newbcast:6 row_mask:0xf bank_mask:0xf
  v_and_b32_dpp v25, v19, v7 row_newbcast:6 row_mask:0xf bank_mask:0xf
  v_and_b32_dpp v26, v19, v8 row_newbcast:6 row_mask:0xf bank_mask:0xf
  v_and_b32_dpp v27, v19, v9 row_newbcast:6 row_mask:0xf bank_mask:0xf
  s_waitcnt vmcnt(2)
  buffer_load_dwordx4 v[48:51], v4, s[32:35], s70 offen offset:1024 nt
  v_mfma_f32_16x16x32_bf16 v[20:23], v[24:27], v[160:163], v[20:23]
  v_and_b32_dpp v28, v19, v6 row_newbcast:14 row_mask:0xf bank_mask:0xf
  v_and_b32_dpp v29, v19, v7 row_newbcast:14 row_mask:0xf bank_mask:0xf
  v_and_b32_dpp v30, v19, v8 row_newbcast:14 row_mask:0xf bank_mask:0xf
  v_and_b32_dpp v31, v19, v9 row_newbcast:14 row_mask:0xf bank_mask:0xf
  s_waitcnt vmcnt(2)
  buffer_load_dwordx4 v[52:55], v4, s[32:35], s70 offen offset:2048 nt
  v_mfma_f32_16x16x32_bf16 v[20:23], v[28:31], v[164:167], v[20:23]
  v_and_b32_dpp v24, v19, v6 row_newbcast:3 row_mask:0xf bank_mask:0xf
  v_and_b32_dpp v25, v19, v7 row_newbcast:3 row_mask:0xf bank_mask:0xf
  v_and_b32_dpp v26, v19, v8 row_newbcast:3 row_mask:0xf bank_mask:0xf
  v_and_b32_dpp v27, v19, v9 row_newbcast:3 row_mask:0xf bank_mask:0xf
  s_waitcnt vmcnt(2)
  buffer_load_dwordx4 v[56:59], v4, s[32:35], s70 offen offset:3072 nt
  v_mfma_f32_16x16x32_bf16 v[20:23], v[24:27], v[44:47], v[20:23]
  v_and_b32_dpp v28, v19, v6 row_newbcast:11 row_mask:0xf bank_mask:0xf
  v_and_b32_dpp v29, v19, v7 row_newbcast:11 row_mask:0xf bank_mask:0xf
  v_and_b32_dpp v30, v19, v8 row_newbcast:11 row_mask:0xf bank_mask:0xf
  v_and_b32_dpp v31, v19, v9 row_newbcast:11 row_mask:0xf bank_mask:0xf
  v_mov_b32 v11, 257
  s_mov_b64 exec, 1
  ds_add_u32 v5, v11 offset:352
  s_mov_b64 exec, -1
  ds_read_b32 v42, v39 offset:320
  s_waitcnt lgkmcnt(0)
  v_cmp_u_f32 s[48:49], v42, v42
  s_waitcnt vmcnt(2)
  v_mfma_f32_16x16x32_bf16 v[20:23], v[28:31], v[48:51], v[20:23]
  v_and_b32_dpp v24, v19, v6 row_newbcast:7 row_mask:0xf bank_mask:0xf
  v_and_b32_dpp v25, v19, v7 row_newbcast:7 row_mask:0xf bank_mask:0xf
  v_and_b32_dpp v26, v19, v8 row_newbcast:7 row_mask:0xf bank_mask:0xf
  v_and_b32_dpp v27, v19, v9 row_newbcast:7 row_mask:0xf bank_mask:0xf
  s_waitcnt vmcnt(1)
  s_nop 0
  v_mfma_f32_16x16x32_bf16 v[20:23], v[24:27], v[52:55], v[20:23]
  v_and_b32_dpp v28, v19, v6 row_newbcast:15 row_mask:0xf bank_mask:0xf
  v_and_b32_dpp v29, v19, v7 row_newbcast:15 row_mask:0xf bank_mask:0xf
  v_and_b32_dpp v30, v19, v8 row_newbcast:15 row_mask:0xf bank_mask:0xf
  v_and_b32_dpp v31, v19, v9 row_newbcast:15 row_mask:0xf bank_mask:0xf
  v_mov_b32 v11, 1
  s_waitcnt vmcnt(0)
  v_mfma_f32_16x16x32_bf16 v[20:23], v[28:31], v[56:59], v[20:23]
  s_cmp_lg_u64 s[48:49], 0
  s_cbranch_scc1 L_refac
L_fac_ok:
  s_nop 6
  v_pk_mul_f32 v[20:21], v[20:21], v[42:43] op_sel:[0,0] op_sel_hi:[1,0]
  v_pk_mul_f32 v[22:23], v[22:23], v[42:43] op_sel:[0,0] op_sel_hi:[1,0]
  s_mov_b32 exec_hi, 0
  ds_write_b128 v36, v[20:23] offset:512
  s_mov_b32 exec_lo, 1
  ds_add_rtn_u32 v11, v5, v11 offset:356
  s_mov_b64 exec, -1
  ds_read_b128 v[60:63], v37 offset:512
  ds_read_b128 v[64:67], v37 offset:1024
  ds_read_b128 v[68:71], v37 offset:1536
  ds_read_b128 v[72:75], v37 offset:2048
  s_waitcnt lgkmcnt(4)
  v_readfirstlane_b32 s76, v11
  s_cmp_lg_u32 s76, 6
  s_nop 2
  s_cbranch_scc1 L_osum_done
  s_waitcnt lgkmcnt(2)
  v_pk_add_f32 v[60:61], v[60:61], v[64:65]
  v_pk_add_f32 v[62:63], v[62:63], v[66:67]
  s_waitcnt lgkmcnt(0)
  v_pk_add_f32 v[68:69], v[68:69], v[72:73]
  v_pk_add_f32 v[70:71], v[70:71], v[74:75]
  v_pk_add_f32 v[60:61], v[60:61], v[68:69]
  v_pk_add_f32 v[62:63], v[62:63], v[70:71]
  s_nop 1
  v_permlane32_swap_b32 v60, v62
  v_permlane32_swap_b32 v61, v63
  v_pk_add_f32 v[60:61], v[60:61], v[62:63]
  v_cvt_pk_bf16_f32 v60, v60, v61
  buffer_store_dword v60, v38, s[52:55], s73 offen sc1
  v_mov_b32 v11, 1
  s_mov_b64 exec, 1
  ds_add_u32 v5, v11 offset:356
  s_mov_b64 exec, -1
L_osum_done:
  s_mov_b32 s87, 0
L_ro:
  ds_read_b32 v41, v5 offset:360
  s_waitcnt lgkmcnt(0)
  v_readfirstlane_b32 s100, v41
  s_movk_i32 s74, 0xff
  s_lshr_b32 s75, s100, 16
  s_and_b32 s100, s100, 0xffff
  s_cmp_lt_u32 s100, 144
  s_cbranch_scc1 L_ffn
  s_cmp_lt_u32 s100, 216
  s_cbranch_scc1 L_stb
  s_cmp_lt_u32 s100, 256
  s_cbranch_scc1 L_fin
  s_sleep 2
  s_add_u32 s87, s87, 1
  s_cmp_lt_u32 s87, 400000
  s_cbranch_scc1 L_ro
  s_branch L_fin
L_stb:
  s_sub_u32 s101, s100, 144
  s_and_b32 s90, s101, 7
  s_waitcnt lgkmcnt(0)
  v_lshrrev_b32 v41, 2, v3
  v_lshl_add_u32 v42, v2, 3, v41
  v_lshlrev_b32 v42, 7, v42
  v_and_b32 v43, 3, v3
  v_lshl_add_u32 v42, v43, 3, v42
  s_lshl_b32 s76, s64, 13
  s_add_u32 s76, s76, 16384
  v_add_u32 v42, s76, v42
  v_lshrrev_b32 v41, 1, v41
  v_and_b32 v36, 1, v2
  v_lshl_add_u32 v41, v36, 1, v41
  v_xor_b32 v32, 0, v41
  v_xor_b32 v33, 1, v41
  v_xor_b32 v34, 2, v41
  v_xor_b32 v35, 3, v41
  v_lshl_add_u32 v32, v32, 5, v42
  v_lshl_add_u32 v33, v33, 5, v42
  v_lshl_add_u32 v34, v34, 5, v42
  v_lshl_add_u32 v35, v35, 5, v42
  v_bfe_u32 v39, v3, 2, 1
  v_lshlrev_b32 v39, 15, v39
  v_lshl_add_u32 v39, v43, 8, v39
  v_lshl_add_u32 v39, v2, 4, v39
  s_lshl_b32 s70, s90, 2
  s_lshr_b32 s76, s64, 1
  s_add_u32 s70, s70, s76
  s_lshl_b32 s70, s70, 10
  s_and_b32 s76, s64, 1
  s_lshl_b32 s76, s76, 7
  s_add_u32 s70, s70, s76
  s_add_u32 s70, s70, 65536
  v_lshlrev_b32 v40, 8, v36
  v_lshrrev_b32 v41, 1, v2
  v_lshl_add_u32 v40, v41, 7, v40
  v_lshl_add_u32 v40, v3, 2, v40
  s_lshl_b32 s76, s64, 9
  s_add_u32 s76, s76, 4608
  v_add_u32 v40, s76, v40
  v_lshlrev_b32 v38, 0, v38
  s_lshl_b32 s76, s101, 8
  s_mul_i32 s72, s64, 18432
  s_add_u32 s72, s72, s76
  s_add_u32 s72, s72, 131072
  s_mov_b32 s87, 0
  v_lshrrev_b32 v41, 3, v3
  v_lshl_add_u32 v39, v41, 6, v39
  s_lshl_b32 s73, s64, 1
  s_add_u32 s73, s73, 1
  s_mov_b32 s71, -1
L_bs:
  ds_read_b32 v41, v5 offset:372
  s_waitcnt lgkmcnt(0)
  v_readfirstlane_b32 s76, v41
  s_cmp_lt_i32 s76, s73
  s_nop 2
  s_cbranch_scc1 L_bs1
  ds_read_b64_tr_b16 v[44:45], v32 offset:0
  ds_read_b64_tr_b16 v[46:47], v32 offset:512
  ds_read_b64_tr_b16 v[48:49], v33 offset:0
  ds_read_b64_tr_b16 v[50:51], v33 offset:512
  ds_read_b64_tr_b16 v[52:53], v34 offset:0
  ds_read_b64_tr_b16 v[54:55], v34 offset:512
  ds_read_b64_tr_b16 v[56:57], v35 offset:0
  ds_read_b64_tr_b16 v[58:59], v35 offset:512
  ds_read_b64_tr_b16 v[60:61], v32 offset:4096
  ds_read_b64_tr_b16 v[62:63], v32 offset:4608
  ds_read_b64_tr_b16 v[64:65], v33 offset:4096
  ds_read_b64_tr_b16 v[66:67], v33 offset:4608
  ds_read_b64_tr_b16 v[68:69], v34 offset:4096
  ds_read_b64_tr_b16 v[70:71], v34 offset:4608
  ds_read_b64_tr_b16 v[72:73], v35 offset:4096
  ds_read_b64_tr_b16 v[74:75], v35 offset:4608
  s_mov_b32 s71, 0
  s_movk_i32 s73, 99
L_bs1:
  s_cmp_ge_i32 s76, 10
  s_cbranch_scc1 L_bs_ok
  s_sleep 1
  s_add_u32 s87, s87, 1
  s_cmp_lt_u32 s87, 400000
  s_cbranch_scc1 L_bs
L_bs_ok:
  s_mov_b32 s87, 0
L_bp:
  buffer_load_dwordx4 v[76:79], v39, s[52:55], s70 offen offset:0 sc1
  s_mov_b64 exec, -1
  s_cmp_ge_i32 s71, 0
  s_cbranch_scc1 L_bp2
  ds_read_b32 v41, v5 offset:372
  s_waitcnt lgkmcnt(0)
  v_readfirstlane_b32 s76, v41
  s_cmp_lt_i32 s76, s73
  s_nop 2
  s_cbranch_scc1 L_bp2
  ds_read_b64_tr_b16 v[44:45], v32 offset:0
  ds_read_b64_tr_b16 v[46:47], v32 offset:512
  ds_read_b64_tr_b16 v[48:49], v33 offset:0
  ds_read_b64_tr_b16 v[50:51], v33 offset:512
  ds_read_b64_tr_b16 v[52:53], v34 offset:0
  ds_read_b64_tr_b16 v[54:55], v34 offset:512
  ds_read_b64_tr_b16 v[56:57], v35 offset:0
  ds_read_b64_tr_b16 v[58:59], v35 offset:512
  ds_read_b64_tr_b16 v[60:61], v32 offset:4096
  ds_read_b64_tr_b16 v[62:63], v32 offset:4608
  ds_read_b64_tr_b16 v[64:65], v33 offset:4096
  ds_read_b64_tr_b16 v[66:67], v33 offset:4608
  ds_read_b64_tr_b16 v[68:69], v34 offset:4096
  ds_read_b64_tr_b16 v[70:71], v34 offset:4608
  ds_read_b64_tr_b16 v[72:73], v35 offset:4096
  ds_read_b64_tr_b16 v[74:75], v35 offset:4608
  s_mov_b32 s71, 0
  s_movk_i32 s73, 99
L_bp2:
  s_waitcnt vmcnt(0)
  v_max3_u32 v41, v76, v77, v78
  v_max_u32 v41, v41, v79
  v_cmp_eq_u32 vcc, -1, v41
  s_waitcnt lgkmcnt(0)
  s_nop 2
  s_cbranch_vccz L_bp_ok
  s_mov_b64 exec, vcc
  s_add_u32 s87, s87, 1
  s_cmp_lt_u32 s87, 60000
  s_cbranch_scc1 L_bp
  s_mov_b64 exec, -1
L_bp_ok:
  s_cmp_ge_i32 s71, 0
  s_cbranch_scc1 L_bw_ok
  s_mov_b32 s87, 0
L_bw:
  ds_read_b32 v41, v5 offset:372
  s_waitcnt lgkmcnt(0)
  v_readfirstlane_b32 s71, v41
  s_cmp_ge_i32 s71, s73
  s_nop 2
  s_cbranch_scc1 L_bw1
  s_sleep 1
  s_add_u32 s87, s87, 1
  s_cmp_lt_u32 s87, 400000
  s_cbranch_scc1 L_bw
L_bw1:
  ds_read_b64_tr_b16 v[44:45], v32 offset:0
  ds_read_b64_tr_b16 v[46:47], v32 offset:512
  ds_read_b64_tr_b16 v[48:49], v33 offset:0
  ds_read_b64_tr_b16 v[50:51], v33 offset:512
  ds_read_b64_tr_b16 v[52:53], v34 offset:0
  ds_read_b64_tr_b16 v[54:55], v34 offset:512
  ds_read_b64_tr_b16 v[56:57], v35 offset:0
  ds_read_b64_tr_b16 v[58:59], v35 offset:512
  ds_read_b64_tr_b16 v[60:61], v32 offset:4096
  ds_read_b64_tr_b16 v[62:63], v32 offset:4608
  ds_read_b64_tr_b16 v[64:65], v33 offset:4096
  ds_read_b64_tr_b16 v[66:67], v33 offset:4608
  ds_read_b64_tr_b16 v[68:69], v34 offset:4096
  ds_read_b64_tr_b16 v[70:71], v34 offset:4608
  ds_read_b64_tr_b16 v[72:73], v35 offset:4096
  ds_read_b64_tr_b16 v[74:75], v35 offset:4608
  s_waitcnt lgkmcnt(0)
L_bw_ok:
  v_mfma_f32_16x16x32_bf16 v[84:87], v[76:79], v[44:47], 0
  v_mov_b32_dpp v80, v76 row_ror:8 row_mask:0xf bank_mask:0xf
  v_mov_b32_dpp v81, v77 row_ror:8 row_mask:0xf bank_mask:0xf
  v_mfma_f32_16x16x32_bf16 v[88:91], v[76:79], v[48:51], 0
  v_mov_b32_dpp v82, v78 row_ror:8 row_mask:0xf bank_mask:0xf
  v_mov_b32_dpp v83, v79 row_ror:8 row_mask:0xf bank_mask:0xf
  v_mfma_f32_16x16x32_bf16 v[92:95], v[76:79], v[52:55], 0
  v_mfma_f32_16x16x32_bf16 v[96:99], v[76:79], v[56:59], 0
  v_mfma_f32_16x16x32_bf16 v[84:87], v[80:83], v[60:63], v[84:87]
  v_mfma_f32_16x16x32_bf16 v[88:91], v[80:83], v[64:67], v[88:91]
  v_mfma_f32_16x16x32_bf16 v[92:95], v[80:83], v[68:71], v[92:95]
  v_mfma_f32_16x16x32_bf16 v[96:99], v[80:83], v[72:75], v[96:99]
  s_nop 4
  v_pk_add_f32 v[84:85], v[84:85], v[86:87]
  v_pk_add_f32 v[88:89], v[88:89], v[90:91]
  v_pk_add_f32 v[92:93], v[92:93], v[94:95]
  v_pk_add_f32 v[96:97], v[96:97], v[98:99]
  v_add_f32 v20, v84, v85
  v_add_f32 v21, v88, v89
  v_add_f32 v22, v92, v93
  v_add_f32 v23, v96, v97
  s_mov_b32 exec_hi, 0
  ds_write2_b32 v40, v20, v21 offset0:0 offset1:16
  ds_write2_b32 v40, v22, v23 offset0:32 offset1:48
  s_mov_b32 exec_hi, -1
  s_cmp_ge_u32 s64, 1
  v_mov_b32 v41, s75
  s_waitcnt lgkmcnt(0)
  s_barrier
  s_cbranch_scc1 L_fin
  ds_read_b128 v[24:27], v37 offset:4608
  ds_read_b128 v[28:31], v37 offset:5120
  ds_read_b128 v[12:15], v37 offset:5632
  ds_read_b128 v[16:19], v37 offset:6144
  s_waitcnt lgkmcnt(2)
  v_pk_add_f32 v[24:25], v[24:25], v[28:29]
  v_pk_add_f32 v[26:27], v[26:27], v[30:31]
  s_waitcnt lgkmcnt(0)
  v_pk_add_f32 v[12:13], v[12:13], v[16:17]
  v_pk_add_f32 v[14:15], v[14:15], v[18:19]
  v_pk_add_f32 v[24:25], v[24:25], v[12:13]
  v_pk_add_f32 v[26:27], v[26:27], v[14:15]
  s_nop 1
  v_permlane32_swap_b32 v24, v26
  v_permlane32_swap_b32 v25, v27
  v_pk_add_f32 v[24:25], v[24:25], v[26:27]
  v_cvt_pk_f16_f32 v24, v24, v25
  buffer_store_dword v24, v38, s[52:55], s72 offen sc1
  s_endpgm
L_ffn:
  s_mov_b32 s56, s4
  s_mov_b32 s57, s5
  s_mov_b32 s58, 2304
  s_mov_b32 s59, 0x20000
  v_and_b32 v41, 3, v3
  v_lshrrev_b32 v43, 1, v41
  v_lshlrev_b32 v40, 6, v43
  v_lshl_add_u32 v40, v2, 4, v40
  v_and_b32 v43, 1, v3
  v_lshl_add_u32 v40, v43, 3, v40
  v_lshlrev_b32 v35, 0, v40
  v_lshrrev_b32 v43, 2, v3
  v_lshl_add_u32 v35, v43, 7, v35
  v_and_b32 v39, 1, v43
  v_mul_u32_u24 v36, 1152, v39
  v_add_u32 v40, v40, v36
  s_lshl_b32 s76, s64, 7
  buffer_load_dwordx2 v[42:43], v40, s[56:59], s76 offen
  v_lshlrev_b32 v39, 6, v39
  v_lshl_add_u32 v39, v2, 4, v39
  v_lshrrev_b32 v36, 2, v3
  v_lshl_add_u32 v34, v2, 3, v36
  v_mul_u32_u24 v34, 1152, v34
  v_lshl_add_u32 v34, v41, 3, v34
  s_add_u32 s76, s76, 90112
  v_add_u32 v34, s76, v34
  v_lshlrev_b32 v36, 6, v36
  v_lshl_add_u32 v36, v41, 3, v36
  v_lshrrev_b32 v41, 1, v2
  v_lshl_add_u32 v36, v41, 11, v36
  v_and_b32 v41, 1, v2
  v_mul_u32_u24 v41, 544, v41
  v_add_u32 v36, v36, v41
  s_lshl_b32 s76, s64, 13
  s_add_u32 s76, s76, 16384
  v_add_u32 v32, s76, v36
  v_xor_b32 v33, 32, v32
  v_lshlrev_b32 v36, 8, v2
  v_lshl_add_u32 v36, v3, 3, v36
  s_lshl_b32 s76, s64, 10
  s_add_u32 s76, s76, 4608
  v_add_u32 v36, s76, v36
  s_lshl_b32 s76, s64, 3
  s_add_u32 s76, s76, 13824
  v_mov_b32 v37, 14080
  v_writelane_b32 v37, s76, 8
  s_add_u32 s77, s76, 4
  v_writelane_b32 v37, s77, 0
  s_add_u32 s76, s76, 128
  v_writelane_b32 v37, s76, 24
  s_add_u32 s77, s76, 4
  v_writelane_b32 v37, s77, 20
  v_lshlrev_b32 v6, 3, v1
  v_and_b32 v9, 0xf8, v6
  v_lshrrev_b32 v7, 5, v1
  v_lshlrev_b32 v7, 7, v7
  v_lshlrev_b32 v8, 1, v1
  s_and_b32 s76, s69, 0
  s_mul_i32 s70, s76, 18432
  s_lshl_b32 s76, s64, 11
  s_add_u32 s70, s70, s76
  s_add_u32 s70, s70, 131072
  s_mov_b32 s76, s100
  v_lshrrev_b32 v38, 3, v1
  v_mul_u32_u24 v38, 9216, v38
  v_and_b32 v41, 7, v1
  v_lshl_add_u32 v38, v41, 3, v38
  s_lshl_b32 s72, s76, 6
  s_mul_i32 s76, s64, 73728
  s_add_u32 s72, s72, s76
  s_add_u32 s72, s72, 458752
  s_mov_b32 s87, 0
  v_mov_b32 v24, s86
  v_mov_b32 v25, s86
  v_mov_b32 v26, s86
  v_mov_b32 v27, s86
  v_mov_b32 v28, s86
  v_mov_b32 v29, s86
  v_mov_b32 v30, s86
  v_mov_b32 v31, s86
  s_mov_b64 s[80:81], -1
  s_mov_b64 s[82:83], -1
  s_mov_b64 s[84:85], -1
  s_mov_b64 s[48:49], -1
  v_and_b32 v95, 1, v2
  v_lshrrev_b32 v94, 3, v3
  v_lshl_add_u32 v95, v95, 1, v94
  v_lshrrev_b32 v94, 2, v3
  v_lshl_add_u32 v94, v2, 3, v94
  v_lshlrev_b32 v94, 7, v94
  v_and_b32 v34, 3, v3
  v_lshl_add_u32 v94, v34, 3, v94
  s_lshl_b32 s77, s64, 12
  s_add_u32 s76, s77, 90112
  v_add_u32 v94, s76, v94
  v_xor_b32 v164, 0, v95
  v_xor_b32 v165, 1, v95
  v_xor_b32 v166, 2, v95
  v_xor_b32 v167, 3, v95
  v_lshl_add_u32 v164, v164, 5, v94
  v_lshl_add_u32 v165, v165, 5, v94
  v_lshl_add_u32 v166, v166, 5, v94
  v_lshl_add_u32 v167, v167, 5, v94
  s_waitcnt vmcnt(37)
  s_barrier
  ds_read_b64_tr_b16 v[44:45], v32 offset:0
  ds_read_b64_tr_b16 v[46:47], v32 offset:256
  ds_read_b64_tr_b16 v[52:53], v33 offset:0
  ds_read_b64_tr_b16 v[54:55], v33 offset:256
  ds_read_b64_tr_b16 v[48:49], v32 offset:4096
  ds_read_b64_tr_b16 v[50:51], v32 offset:4352
  ds_read_b64_tr_b16 v[56:57], v33 offset:4096
  ds_read_b64_tr_b16 v[58:59], v33 offset:4352
  ds_read_b64_tr_b16 v[60:61], v32 offset:1024
  ds_read_b64_tr_b16 v[62:63], v32 offset:1280
  ds_read_b64_tr_b16 v[68:69], v33 offset:1024
  ds_read_b64_tr_b16 v[70:71], v33 offset:1280
  ds_read_b64_tr_b16 v[64:65], v32 offset:5120
  ds_read_b64_tr_b16 v[66:67], v32 offset:5376
  ds_read_b64_tr_b16 v[72:73], v33 offset:5120
  ds_read_b64_tr_b16 v[74:75], v33 offset:5376
  s_waitcnt vmcnt(21)
  s_barrier
  buffer_load_dwordx2 v[148:149], v35, s[52:55], s70 offen offset:0 sc1
  buffer_load_dwordx2 v[152:153], v35, s[52:55], s70 offen offset:512 sc1
  buffer_load_dwordx2 v[156:157], v35, s[52:55], s70 offen offset:1024 sc1
  buffer_load_dwordx2 v[160:161], v35, s[52:55], s70 offen offset:1536 sc1
  s_waitcnt vmcnt(4) lgkmcnt(0)
  s_barrier
  ds_read_b64_tr_b16 v[76:77], v164 offset:0
  ds_read_b64_tr_b16 v[78:79], v164 offset:512
  ds_read_b64_tr_b16 v[80:81], v165 offset:0
  ds_read_b64_tr_b16 v[82:83], v165 offset:512
  ds_read_b64_tr_b16 v[84:85], v166 offset:0
  ds_read_b64_tr_b16 v[86:87], v166 offset:512
  ds_read_b64_tr_b16 v[88:89], v167 offset:0
  ds_read_b64_tr_b16 v[90:91], v167 offset:512
  v_lshlrev_b32 v12, 16, v42
  v_and_b32 v13, 0xffff0000, v42
  v_lshlrev_b32 v14, 16, v43
  v_and_b32 v15, 0xffff0000, v43
  s_nop 0
  s_branch L_hp2
L_hp:
  s_or_b64 exec, s[80:81], 1
  buffer_load_dwordx2 v[148:149], v35, s[52:55], s70 offen offset:0 sc1
  s_or_b64 exec, s[82:83], 1
  buffer_load_dwordx2 v[152:153], v35, s[52:55], s70 offen offset:512 sc1
  s_or_b64 exec, s[84:85], 1
  buffer_load_dwordx2 v[156:157], v35, s[52:55], s70 offen offset:1024 sc1
  s_or_b64 exec, s[48:49], 1
  buffer_load_dwordx2 v[160:161], v35, s[52:55], s70 offen offset:1536 sc1
  s_mov_b64 exec, -1
L_hp2:
  s_waitcnt vmcnt(2)
  v_fma_mix_f32 v20, v148, 1.0, v152 op_sel:[0,0,0] op_sel_hi:[1,0,1]
  v_fma_mix_f32 v21, v148, 1.0, v152 op_sel:[1,0,1] op_sel_hi:[1,0,1]
  v_fma_mix_f32 v22, v149, 1.0, v153 op_sel:[0,0,0] op_sel_hi:[1,0,1]
  v_fma_mix_f32 v23, v149, 1.0, v153 op_sel:[1,0,1] op_sel_hi:[1,0,1]
  v_max_u32 v144, v148, v149
  v_max_u32 v145, v152, v153
  s_waitcnt vmcnt(0)
  v_fma_mix_f32 v16, v156, 1.0, v160 op_sel:[0,0,0] op_sel_hi:[1,0,1]
  v_fma_mix_f32 v17, v156, 1.0, v160 op_sel:[1,0,1] op_sel_hi:[1,0,1]
  v_fma_mix_f32 v18, v157, 1.0, v161 op_sel:[0,0,0] op_sel_hi:[1,0,1]
  v_fma_mix_f32 v19, v157, 1.0, v161 op_sel:[1,0,1] op_sel_hi:[1,0,1]
  v_pk_add_f32 v[20:21], v[20:21], v[16:17]
  v_pk_add_f32 v[22:23], v[22:23], v[18:19]
  v_max_u32 v146, v156, v157
  v_max_u32 v147, v160, v161
  v_add_f32_dpp v20, v20, v20 row_ror:8 row_mask:0xf bank_mask:0xf
  v_add_f32_dpp v21, v21, v21 row_ror:8 row_mask:0xf bank_mask:0xf
  v_max3_u32 v41, v144, v145, v146
  v_add_f32_dpp v22, v22, v22 row_ror:8 row_mask:0xf bank_mask:0xf
  v_add_f32_dpp v23, v23, v23 row_ror:8 row_mask:0xf bank_mask:0xf
  v_max_u32 v41, v41, v147
  v_cvt_pk_bf16_f32 v18, v20, v21
  v_cmp_eq_u32 vcc, -1, v41
  v_cvt_pk_bf16_f32 v19, v22, v23
  v_lshlrev_b32 v20, 16, v18
  v_and_b32 v21, 0xffff0000, v18
  v_lshlrev_b32 v22, 16, v19
  v_and_b32 v23, 0xffff0000, v19
  s_nop 0
  s_cbranch_vccz L_hp_ok
  v_cmp_eq_u32 s[80:81], -1, v144
  v_cmp_eq_u32 s[82:83], -1, v145
  v_cmp_eq_u32 s[84:85], -1, v146
  v_cmp_eq_u32 s[48:49], -1, v147
  s_add_u32 s87, s87, 1
  s_cmp_lt_u32 s87, 60000
  s_nop 1
  s_cbranch_scc1 L_hp
L_hp_ok:
  v_pk_add_f32 v[20:21], v[20:21], v[12:13]
  v_pk_add_f32 v[22:23], v[22:23], v[14:15]
  v_cvt_pk_bf16_f32 v16, v20, v21
  v_cvt_pk_bf16_f32 v17, v22, v23
  s_nop 0
  v_mov_b32_dpp v24, v16 quad_perm:[0,0,0,0] row_mask:0xf bank_mask:0x3
  v_mov_b32_dpp v26, v16 quad_perm:[1,1,1,1] row_mask:0xf bank_mask:0x3
  v_mov_b32_dpp v25, v17 quad_perm:[0,0,0,0] row_mask:0xf bank_mask:0x3
  v_mov_b32_dpp v27, v17 quad_perm:[1,1,1,1] row_mask:0xf bank_mask:0x3
  v_mov_b32_dpp v28, v16 quad_perm:[2,2,2,2] row_mask:0xf bank_mask:0x3
  v_mov_b32_dpp v30, v16 quad_perm:[3,3,3,3] row_mask:0xf bank_mask:0x3
  v_mfma_f32_16x16x32_bf16 v[124:127], v[24:27], v[24:27], 0
  v_mov_b32_dpp v29, v17 quad_perm:[2,2,2,2] row_mask:0xf bank_mask:0x3
  v_mfma_f32_16x16x32_bf16 v[108:111], v[24:27], v[44:47], 0
  v_mov_b32_dpp v31, v17 quad_perm:[3,3,3,3] row_mask:0xf bank_mask:0x3
  v_mfma_f32_16x16x32_bf16 v[112:115], v[24:27], v[60:63], 0
  v_mfma_f32_16x16x32_bf16 v[116:119], v[24:27], v[52:55], 0
  v_mfma_f32_16x16x32_bf16 v[120:123], v[24:27], v[68:71], 0
  v_mfma_f32_16x16x32_bf16 v[124:127], v[28:31], v[28:31], v[124:127]
  v_mfma_f32_16x16x32_bf16 v[108:111], v[28:31], v[48:51], v[108:111]
  v_mfma_f32_16x16x32_bf16 v[112:115], v[28:31], v[64:67], v[112:115]
  v_mfma_f32_16x16x32_bf16 v[116:119], v[28:31], v[56:59], v[116:119]
  v_mfma_f32_16x16x32_bf16 v[120:123], v[28:31], v[72:75], v[120:123]
  s_mov_b64 exec, 0x1100101
  s_nop 2
  ds_write_b32 v37, v124
  s_mov_b64 exec, -1
  ds_write2_b32 v36, v108, v112 offset0:0 offset1:1
  s_nop 0
  ds_write2_b32 v36, v116, v120 offset0:32 offset1:33
  s_cmp_lg_u32 s64, 0
  s_waitcnt lgkmcnt(0)
  s_barrier
  s_cbranch_scc1 L_act_done
  ds_read_b128 v[44:47], v7 offset:13824
  ds_read_b128 v[48:51], v7 offset:13840
  ds_read_b128 v[52:55], v7 offset:13856
  ds_read_b128 v[56:59], v7 offset:13872
  ds_read_b64 v[60:61], v7 offset:13888
  ds_read_b64 v[64:65], v6 offset:4608
  ds_read_b64 v[66:67], v6 offset:5632
  ds_read_b64 v[68:69], v6 offset:6656
  ds_read_b64 v[70:71], v6 offset:7680
  ds_read_b64 v[72:73], v6 offset:8704
  ds_read_b64 v[74:75], v6 offset:9728
  ds_read_b64 v[92:93], v6 offset:10752
  ds_read_b64 v[94:95], v6 offset:11776
  ds_read_b64 v[96:97], v6 offset:12800
  s_waitcnt lgkmcnt(9)
  ds_read_b64 v[100:101], v9 offset:5120
  ds_read_b64 v[102:103], v9 offset:6144
  ds_read_b64 v[104:105], v9 offset:7168
  ds_read_b64 v[106:107], v9 offset:8192
  ds_read_b64 v[108:109], v9 offset:9216
  ds_read_b64 v[110:111], v9 offset:10240
  v_pk_add_f32 v[44:45], v[44:45], v[46:47]
  v_pk_add_f32 v[48:49], v[48:49], v[50:51]
  v_pk_add_f32 v[52:53], v[52:53], v[54:55]
  v_pk_add_f32 v[56:57], v[56:57], v[58:59]
  v_pk_add_f32 v[44:45], v[44:45], v[48:49]
  v_pk_add_f32 v[52:53], v[52:53], v[56:57]
  v_pk_add_f32 v[44:45], v[44:45], v[60:61]
  v_pk_add_f32 v[44:45], v[44:45], v[52:53]
  s_waitcnt lgkmcnt(6)
  ds_read_b64 v[112:113], v9 offset:11264
  ds_read_b64 v[114:115], v9 offset:12288
  ds_read_b64 v[116:117], v9 offset:13312
  v_mul_f32 v44, s91, v44
  v_pk_add_f32 v[64:65], v[64:65], v[66:67]
  v_mul_f32 v48, v44, v44
  v_pk_add_f32 v[68:69], v[68:69], v[70:71]
  v_fma_f32 v45, v45, s91, -v48
  v_pk_add_f32 v[72:73], v[72:73], v[74:75]
  v_max_f32 v45, 0, v45
  v_pk_add_f32 v[92:93], v[92:93], v[94:95]
  v_cvt_pk_bf16_f32 v45, v45, v45
  v_pk_add_f32 v[64:65], v[64:65], v[68:69]
  v_and_b32 v45, 0xffff0000, v45
  v_pk_add_f32 v[72:73], v[72:73], v[92:93]
  v_add_f32 v45, 0x3727c5ac, v45
  v_pk_add_f32 v[64:65], v[64:65], v[96:97]
  v_cvt_pk_bf16_f32 v45, v45, v45
  v_pk_add_f32 v[64:65], v[64:65], v[72:73]
  v_and_b32 v45, 0xffff0000, v45
  s_waitcnt lgkmcnt(0)
  v_pk_add_f32 v[100:101], v[100:101], v[102:103]
  v_sqrt_f32 v45, v45
  v_pk_add_f32 v[104:105], v[104:105], v[106:107]
  v_cvt_pk_bf16_f32 v44, v44, v44
  v_pk_add_f32 v[108:109], v[108:109], v[110:111]
  v_and_b32 v44, 0xffff0000, v44
  v_pk_add_f32 v[112:113], v[112:113], v[114:115]
  v_cvt_pk_bf16_f32 v45, v45, v45
  v_pk_add_f32 v[100:101], v[100:101], v[104:105]
  v_and_b32 v45, 0xffff0000, v45
  v_pk_add_f32 v[108:109], v[108:109], v[112:113]
  v_rcp_f32 v45, v45
  v_pk_add_f32 v[100:101], v[100:101], v[116:117]
  v_pk_add_f32 v[100:101], v[100:101], v[108:109]
  v_pk_fma_f32 v[64:65], v[100:101], v[44:45], v[64:65] op_sel:[0,0,0] op_sel_hi:[1,0,1] neg_lo:[0,1,0] neg_hi:[0,1,0]
  v_pk_mul_f32 v[64:65], v[64:65], v[44:45] op_sel:[0,1] op_sel_hi:[1,1]
  v_mov_b32 v69, 0xc0135761
  v_cvt_pk_bf16_f32 v65, v64, v65
  v_lshlrev_b32 v64, 16, v65
  v_mul_f32 v68, v64, v64
  v_fmac_f32 v69, 0xbdd2d3e8, v68
  v_mul_f32 v68, v69, v64
  v_exp_f32 v68, v68
  v_and_b32 v65, 0xffff0000, v65
  v_add_f32 v68, 1.0, v68
  v_rcp_f32 v68, v68
  s_nop 0
  v_mul_f32 v68, v68, v64
  v_cvt_pk_bf16_f32 v68, v68, v68
  v_and_b32 v68, 0xffff0000, v68
  v_mul_f32 v68, v68, v65
  v_cvt_pk_bf16_f32 v68, v68, v68
  ds_write_b16 v8, v68 offset:14336
  s_waitcnt lgkmcnt(0)
L_act_done:
  s_barrier
  ds_read_b128 v[24:27], v39 offset:14336
  v_mov_b32 v41, s75
  s_waitcnt lgkmcnt(0)
  v_mfma_f32_16x16x32_bf16 v[80:83], v[24:27], v[80:83], 0
  v_mfma_f32_16x16x32_bf16 v[84:87], v[24:27], v[84:87], 0
  v_mfma_f32_16x16x32_bf16 v[88:91], v[24:27], v[88:91], 0
  v_mfma_f32_16x16x32_bf16 v[76:79], v[24:27], v[76:79], 0
  s_nop 5
  v_mov_b32_dpp v80, v84 quad_perm:[0,1,2,3] row_mask:0xc bank_mask:0xf
  v_mov_b32_dpp v81, v88 quad_perm:[0,1,2,3] row_mask:0xc bank_mask:0xf
  v_mov_b32_dpp v80, v76 quad_perm:[0,1,2,3] row_mask:0x3 bank_mask:0xf
  v_bfi_b32 v81, s74, v41, v81
  v_bfi_b32 v80, s74, v41, v80
  buffer_store_dwordx2 v[80:81], v38, s[52:55], s72 offen sc1
  s_endpgm
L_refac:
  s_mov_b32 s87, 0
L_refac1:
  ds_read_b32 v42, v39 offset:320
  s_waitcnt lgkmcnt(0)
  v_cmp_u_f32 s[48:49], v42, v42
  s_cmp_eq_u64 s[48:49], 0
  s_nop 2
  s_cbranch_scc1 L_fac_ok
  s_sleep 2
  s_add_u32 s87, s87, 1
  s_cmp_lt_u32 s87, 400000
  s_cbranch_scc1 L_refac1
  s_branch L_fac_ok
L_help:
  s_setprio 3
  v_mov_b32 v144, -1
  v_mov_b32 v145, -1
  v_mov_b32 v146, -1
  v_mov_b32 v147, -1
  s_mov_b64 exec, 0xffffff
  ds_write_b128 v33, v[144:147]
  s_mov_b64 exec, -1
  v_lshrrev_b32 v34, 5, v1
  v_mul_u32_u24 v34, 1152, v34
  v_and_b32 v35, 31, v1
  v_lshl_add_u32 v36, v35, 4, v34
  v_lshl_add_u32 v35, v35, 2, v34
  s_and_b32 s76, s65, 3
  s_lshl_b32 s74, s76, 1
  s_add_u32 s74, s74, s66
  s_mul_i32 s73, s74, 144
  v_lshlrev_b32 v34, 3, v3
  v_lshl_add_u32 v34, v2, 1, v34
  s_lshl_b32 s76, s67, 8
  s_sub_u32 s38, 4718592, s76
  s_mov_b32 s39, 0x20000
  s_mul_i32 s72, s74, 589824
  v_lshlrev_b32 v4, 13, v2
  v_lshl_add_u32 v4, v3, 4, v4
  s_mov_b32 s58, 2304
  s_mov_b32 s59, 0x20000
  s_waitcnt lgkmcnt(0)
  s_mov_b32 s56, s4
  s_mov_b32 s57, s5
  s_add_u32 s36, s10, s76
  s_addc_u32 s37, s11, 0
  s_load_dword s75, s[26:27], 0
  buffer_load_dwordx4 v[148:151], v36, s[56:59], 0 offen
  buffer_load_dwordx4 v[152:155], v36, s[56:59], 0 offen offset:512
  buffer_load_dword v12, v35, s[56:59], 0 offen offset:1024
  s_mul_i32 s76, s66, 1152
  s_xor_b32 s77, s74, 1
  s_mul_i32 s89, s77, 589824
  s_mul_i32 s77, s77, 144
  s_add_u32 s73, s73, s76
  s_add_u32 s77, s77, s76
  buffer_load_ushort v156, v34, s[56:59], s73 offen
  buffer_load_ushort v157, v34, s[56:59], s73 offen offset:128
  buffer_load_ushort v158, v34, s[56:59], s77 offen
  buffer_load_ushort v159, v34, s[56:59], s77 offen offset:128
  buffer_load_dwordx4 v[44:47], v4, s[36:39], s72 offen nt
  s_add_u32 s72, s72, 0x8000
  buffer_load_dwordx4 v[48:51], v4, s[36:39], s72 offen nt
  s_add_u32 s72, s72, 0x8000
  buffer_load_dwordx4 v[52:55], v4, s[36:39], s72 offen nt
  s_add_u32 s72, s72, 0x8000
  buffer_load_dwordx4 v[56:59], v4, s[36:39], s72 offen nt
  s_add_u32 s72, s72, 0x8000
  buffer_load_dwordx4 v[60:63], v4, s[36:39], s72 offen nt
  s_add_u32 s72, s72, 0x8000
  buffer_load_dwordx4 v[64:67], v4, s[36:39], s72 offen nt
  s_add_u32 s72, s72, 0x8000
  buffer_load_dwordx4 v[68:71], v4, s[36:39], s72 offen nt
  s_add_u32 s72, s72, 0x8000
  buffer_load_dwordx4 v[72:75], v4, s[36:39], s72 offen nt
  s_add_u32 s72, s72, 0x8000
  buffer_load_dwordx4 v[76:79], v4, s[36:39], s72 offen nt
  s_add_u32 s72, s72, 0x8000
  buffer_load_dwordx4 v[80:83], v4, s[36:39], s72 offen nt
  s_add_u32 s72, s72, 0x8000
  buffer_load_dwordx4 v[84:87], v4, s[36:39], s72 offen nt
  s_add_u32 s72, s72, 0x8000
  buffer_load_dwordx4 v[88:91], v4, s[36:39], s72 offen nt
  s_add_u32 s72, s72, 0x8000
  buffer_load_dwordx4 v[92:95], v4, s[36:39], s72 offen nt
  s_add_u32 s72, s72, 0x8000
  buffer_load_dwordx4 v[96:99], v4, s[36:39], s72 offen nt
  s_add_u32 s72, s72, 0x8000
  buffer_load_dwordx4 v[100:103], v4, s[36:39], s72 offen nt
  s_add_u32 s72, s72, 0x8000
  buffer_load_dwordx4 v[104:107], v4, s[36:39], s72 offen nt
  s_add_u32 s72, s72, 0x8000
  buffer_load_dwordx4 v[108:111], v4, s[36:39], s72 offen nt
  s_add_u32 s72, s72, 0x8000
  buffer_load_dwordx4 v[112:115], v4, s[36:39], s72 offen nt
  s_mov_b32 s72, s89
  buffer_load_dwordx4 v[116:119], v4, s[36:39], s72 offen nt
  s_add_u32 s72, s72, 0x8000
  buffer_load_dwordx4 v[120:123], v4, s[36:39], s72 offen nt
  s_add_u32 s72, s72, 0x8000
  buffer_load_dwordx4 v[124:127], v4, s[36:39], s72 offen nt
  s_add_u32 s72, s72, 0x8000
  buffer_load_dwordx4 v[128:131], v4, s[36:39], s72 offen nt
  s_add_u32 s72, s72, 0x8000
  buffer_load_dwordx4 v[132:135], v4, s[36:39], s72 offen nt
  s_add_u32 s72, s72, 0x8000
  buffer_load_dwordx4 v[136:139], v4, s[36:39], s72 offen nt
  s_add_u32 s72, s72, 0x8000
  s_barrier
  s_mov_b32 s52, s26
  s_mov_b32 s53, s27
  s_mov_b32 s54, 2097152
  s_mov_b32 s55, 0x20000
  v_and_b32 v37, 1, v1
  v_lshlrev_b32 v37, 4, v37
  v_mov_b32 v39, 0xffff
  v_lshlrev_b32 v37, v37, v39
  v_bfe_u32 v39, v1, 1, 2
  v_cmp_eq_u32 vcc, 0, v39
  s_nop 1
  v_cndmask_b32 v6, 0, v37, vcc
  v_cmp_eq_u32 vcc, 1, v39
  s_nop 1
  v_cndmask_b32 v7, 0, v37, vcc
  v_cmp_eq_u32 vcc, 2, v39
  s_nop 1
  v_cndmask_b32 v8, 0, v37, vcc
  v_cmp_eq_u32 vcc, 3, v39
  s_nop 1
  v_cndmask_b32 v9, 0, v37, vcc
  s_mov_b32 s86, 0x3f803f80
  s_mov_b32 s91, 0x3ae38e39
  v_mov_b32 v5, 0
  s_waitcnt vmcnt(24)
  v_dot2_f32_bf16 v40, v148, s86, 0
  v_dot2_f32_bf16 v41, v148, v148, 0
  v_dot2_f32_bf16 v40, v149, s86, v40
  v_dot2_f32_bf16 v41, v149, v149, v41
  v_dot2_f32_bf16 v40, v150, s86, v40
  v_dot2_f32_bf16 v41, v150, v150, v41
  v_dot2_f32_bf16 v40, v151, s86, v40
  v_dot2_f32_bf16 v41, v151, v151, v41
  v_dot2_f32_bf16 v40, v152, s86, v40
  v_dot2_f32_bf16 v41, v152, v152, v41
  v_dot2_f32_bf16 v40, v153, s86, v40
  v_dot2_f32_bf16 v41, v153, v153, v41
  v_dot2_f32_bf16 v40, v154, s86, v40
  v_dot2_f32_bf16 v41, v154, v154, v41
  v_dot2_f32_bf16 v40, v155, s86, v40
  v_dot2_f32_bf16 v41, v155, v155, v41
  v_dot2_f32_bf16 v40, v12, s86, v40
  v_dot2_f32_bf16 v41, v12, v12, v41
  s_nop 1
  v_add_f32_dpp v40, v40, v40 row_ror:8 row_mask:0xf bank_mask:0xf
  v_add_f32_dpp v41, v41, v41 row_ror:8 row_mask:0xf bank_mask:0xf
  s_nop 0
  v_add_f32_dpp v40, v40, v40 row_ror:4 row_mask:0xf bank_mask:0xf
  v_add_f32_dpp v41, v41, v41 row_ror:4 row_mask:0xf bank_mask:0xf
  s_nop 0
  v_add_f32_dpp v40, v40, v40 row_ror:2 row_mask:0xf bank_mask:0xf
  v_add_f32_dpp v41, v41, v41 row_ror:2 row_mask:0xf bank_mask:0xf
  s_nop 0
  v_add_f32_dpp v40, v40, v40 row_ror:1 row_mask:0xf bank_mask:0xf
  v_add_f32_dpp v41, v41, v41 row_ror:1 row_mask:0xf bank_mask:0xf
  v_mov_b32 v42, v40
  v_mov_b32 v43, v41
  s_nop 0
  v_permlane16_swap_b32 v40, v42
  v_permlane16_swap_b32 v41, v43
  v_add_f32 v40, v40, v42
  v_add_f32 v41, v41, v43
  v_mul_f32 v40, s91, v40
  v_mul_f32 v42, v40, v40
  v_fma_f32 v41, v41, s91, -v42
  v_max_f32 v41, 0, v41
  v_cvt_pk_bf16_f32 v41, v41, v41
  v_and_b32 v41, 0xffff0000, v41
  v_add_f32 v41, 0x3727c5ac, v41
  v_cvt_pk_bf16_f32 v41, v41, v41
  v_and_b32 v41, 0xffff0000, v41
  v_sqrt_f32 v41, v41
  v_cvt_pk_bf16_f32 v40, v40, v40
  v_and_b32 v40, 0xffff0000, v40
  v_cvt_pk_bf16_f32 v41, v41, v41
  v_and_b32 v41, 0xffff0000, v41
  v_rcp_f32 v41, v41
  s_lshl_b32 s88, s66, 5
  v_readlane_b32 s76, v40, s88
  v_readlane_b32 s77, v40, s88
  v_readlane_b32 s96, v41, s88
  v_readlane_b32 s97, v41, s88
  v_lshlrev_b32 v156, 16, v156
  v_lshlrev_b32 v157, 16, v157
  v_lshlrev_b32 v158, 16, v158
  v_lshlrev_b32 v159, 16, v159
  v_subrev_f32 v156, s76, v156
  v_subrev_f32 v157, s76, v157
  v_subrev_f32 v158, s77, v158
  v_subrev_f32 v159, s77, v159
  v_cvt_pk_bf16_f32 v156, v156, v156
  v_and_b32 v156, 0xffff0000, v156
  v_cvt_pk_bf16_f32 v157, v157, v157
  v_and_b32 v157, 0xffff0000, v157
  v_cvt_pk_bf16_f32 v158, v158, v158
  v_and_b32 v158, 0xffff0000, v158
  v_cvt_pk_bf16_f32 v159, v159, v159
  v_and_b32 v159, 0xffff0000, v159
  v_mul_f32 v156, s96, v156
  v_mul_f32 v157, s96, v157
  v_mul_f32 v158, s97, v158
  v_mul_f32 v159, s97, v159
  v_cvt_pk_bf16_f32 v156, v156, v156
  v_cvt_pk_bf16_f32 v157, v157, v157
  v_cvt_pk_bf16_f32 v158, v158, v158
  v_cvt_pk_bf16_f32 v159, v159, v159
  v_and_b32_dpp v24, v156, v6 row_newbcast:0 row_mask:0xf bank_mask:0xf
  v_and_b32_dpp v25, v156, v7 row_newbcast:0 row_mask:0xf bank_mask:0xf
  v_and_b32_dpp v26, v156, v8 row_newbcast:0 row_mask:0xf bank_mask:0xf
  v_and_b32_dpp v27, v156, v9 row_newbcast:0 row_mask:0xf bank_mask:0xf
  s_waitcnt vmcnt(23)
  s_nop 0
  v_mfma_f32_16x16x32_bf16 v[20:23], v[24:27], v[44:47], 0
  buffer_load_dwordx4 v[44:47], v4, s[36:39], s72 offen nt
  s_add_u32 s72, s72, 0x8000
  v_and_b32_dpp v28, v156, v6 row_newbcast:1 row_mask:0xf bank_mask:0xf
  v_and_b32_dpp v29, v156, v7 row_newbcast:1 row_mask:0xf bank_mask:0xf
  v_and_b32_dpp v30, v156, v8 row_newbcast:1 row_mask:0xf bank_mask:0xf
  v_and_b32_dpp v31, v156, v9 row_newbcast:1 row_mask:0xf bank_mask:0xf
  s_waitcnt vmcnt(23)
  s_nop 0
  v_mfma_f32_16x16x32_bf16 v[20:23], v[28:31], v[48:51], v[20:23]
  buffer_load_dwordx4 v[48:51], v4, s[36:39], s72 offen nt
  s_add_u32 s72, s72, 0x8000
  v_and_b32_dpp v24, v156, v6 row_newbcast:2 row_mask:0xf bank_mask:0xf
  v_and_b32_dpp v25, v156, v7 row_newbcast:2 row_mask:0xf bank_mask:0xf
  v_and_b32_dpp v26, v156, v8 row_newbcast:2 row_mask:0xf bank_mask:0xf
  v_and_b32_dpp v27, v156, v9 row_newbcast:2 row_mask:0xf bank_mask:0xf
  s_waitcnt vmcnt(23)
  s_nop 0
  v_mfma_f32_16x16x32_bf16 v[20:23], v[24:27], v[52:55], v[20:23]
  buffer_load_dwordx4 v[52:55], v4, s[36:39], s72 offen nt
  s_add_u32 s72, s72, 0x8000
  v_and_b32_dpp v28, v156, v6 row_newbcast:3 row_mask:0xf bank_mask:0xf
  v_and_b32_dpp v29, v156, v7 row_newbcast:3 row_mask:0xf bank_mask:0xf
  v_and_b32_dpp v30, v156, v8 row_newbcast:3 row_mask:0xf bank_mask:0xf
  v_and_b32_dpp v31, v156, v9 row_newbcast:3 row_mask:0xf bank_mask:0xf
  s_waitcnt vmcnt(23)
  s_nop 0
  v_mfma_f32_16x16x32_bf16 v[20:23], v[28:31], v[56:59], v[20:23]
  buffer_load_dwordx4 v[56:59], v4, s[36:39], s72 offen nt
  s_add_u32 s72, s72, 0x8000
  v_and_b32_dpp v24, v156, v6 row_newbcast:4 row_mask:0xf bank_mask:0xf
  v_and_b32_dpp v25, v156, v7 row_newbcast:4 row_mask:0xf bank_mask:0xf
  v_and_b32_dpp v26, v156, v8 row_newbcast:4 row_mask:0xf bank_mask:0xf
  v_and_b32_dpp v27, v156, v9 row_newbcast:4 row_mask:0xf bank_mask:0xf
  s_waitcnt vmcnt(23)
  s_nop 0
  v_mfma_f32_16x16x32_bf16 v[20:23], v[24:27], v[60:63], v[20:23]
  buffer_load_dwordx4 v[60:63], v4, s[36:39], s72 offen nt
  s_add_u32 s72, s72, 0x8000
  v_and_b32_dpp v28, v156, v6 row_newbcast:5 row_mask:0xf bank_mask:0xf
  v_and_b32_dpp v29, v156, v7 row_newbcast:5 row_mask:0xf bank_mask:0xf
  v_and_b32_dpp v30, v156, v8 row_newbcast:5 row_mask:0xf bank_mask:0xf
  v_and_b32_dpp v31, v156, v9 row_newbcast:5 row_mask:0xf bank_mask:0xf
  s_waitcnt vmcnt(23)
  s_nop 0
  v_mfma_f32_16x16x32_bf16 v[20:23], v[28:31], v[64:67], v[20:23]
  buffer_load_dwordx4 v[64:67], v4, s[36:39], s72 offen nt
  s_add_u32 s72, s72, 0x8000
  v_and_b32_dpp v24, v156, v6 row_newbcast:6 row_mask:0xf bank_mask:0xf
  v_and_b32_dpp v25, v156, v7 row_newbcast:6 row_mask:0xf bank_mask:0xf
  v_and_b32_dpp v26, v156, v8 row_newbcast:6 row_mask:0xf bank_mask:0xf
  v_and_b32_dpp v27, v156, v9 row_newbcast:6 row_mask:0xf bank_mask:0xf
  s_waitcnt vmcnt(23)
  s_nop 0
  v_mfma_f32_16x16x32_bf16 v[20:23], v[24:27], v[68:71], v[20:23]
  buffer_load_dwordx4 v[68:71], v4, s[36:39], s72 offen nt
  s_add_u32 s72, s72, 0x8000
  v_and_b32_dpp v28, v156, v6 row_newbcast:7 row_mask:0xf bank_mask:0xf
  v_and_b32_dpp v29, v156, v7 row_newbcast:7 row_mask:0xf bank_mask:0xf
  v_and_b32_dpp v30, v156, v8 row_newbcast:7 row_mask:0xf bank_mask:0xf
  v_and_b32_dpp v31, v156, v9 row_newbcast:7 row_mask:0xf bank_mask:0xf
  s_waitcnt vmcnt(23)
  s_nop 0
  v_mfma_f32_16x16x32_bf16 v[20:23], v[28:31], v[72:75], v[20:23]
  buffer_load_dwordx4 v[72:75], v4, s[36:39], s72 offen nt
  s_add_u32 s72, s72, 0x8000
  v_and_b32_dpp v24, v156, v6 row_newbcast:8 row_mask:0xf bank_mask:0xf
  v_and_b32_dpp v25, v156, v7 row_newbcast:8 row_mask:0xf bank_mask:0xf
  v_and_b32_dpp v26, v156, v8 row_newbcast:8 row_mask:0xf bank_mask:0xf
  v_and_b32_dpp v27, v156, v9 row_newbcast:8 row_mask:0xf bank_mask:0xf
  s_waitcnt vmcnt(23)
  s_nop 0
  v_mfma_f32_16x16x32_bf16 v[20:23], v[24:27], v[76:79], v[20:23]
  buffer_load_dwordx4 v[76:79], v4, s[36:39], s72 offen nt
  s_add_u32 s72, s72, 0x8000
  v_and_b32_dpp v28, v156, v6 row_newbcast:9 row_mask:0xf bank_mask:0xf
  v_and_b32_dpp v29, v156, v7 row_newbcast:9 row_mask:0xf bank_mask:0xf
  v_and_b32_dpp v30, v156, v8 row_newbcast:9 row_mask:0xf bank_mask:0xf
  v_and_b32_dpp v31, v156, v9 row_newbcast:9 row_mask:0xf bank_mask:0xf
  s_waitcnt vmcnt(23)
  s_nop 0
  v_mfma_f32_16x16x32_bf16 v[20:23], v[28:31], v[80:83], v[20:23]
  buffer_load_dwordx4 v[80:83], v4, s[36:39], s72 offen nt
  s_add_u32 s72, s72, 0x8000
  v_and_b32_dpp v24, v156, v6 row_newbcast:10 row_mask:0xf bank_mask:0xf
  v_and_b32_dpp v25, v156, v7 row_newbcast:10 row_mask:0xf bank_mask:0xf
  v_and_b32_dpp v26, v156, v8 row_newbcast:10 row_mask:0xf bank_mask:0xf
  v_and_b32_dpp v27, v156, v9 row_newbcast:10 row_mask:0xf bank_mask:0xf
  s_waitcnt vmcnt(23)
  s_nop 0
  v_mfma_f32_16x16x32_bf16 v[20:23], v[24:27], v[84:87], v[20:23]
  buffer_load_dwordx4 v[84:87], v4, s[36:39], s72 offen nt
  s_add_u32 s72, s72, 0x8000
  v_and_b32_dpp v28, v156, v6 row_newbcast:11 row_mask:0xf bank_mask:0xf
  v_and_b32_dpp v29, v156, v7 row_newbcast:11 row_mask:0xf bank_mask:0xf
  v_and_b32_dpp v30, v156, v8 row_newbcast:11 row_mask:0xf bank_mask:0xf
  v_and_b32_dpp v31, v156, v9 row_newbcast:11 row_mask:0xf bank_mask:0xf
  s_waitcnt vmcnt(23)
  s_nop 0
  v_mfma_f32_16x16x32_bf16 v[20:23], v[28:31], v[88:91], v[20:23]
  buffer_load_dwordx4 v[88:91], v4, s[36:39], s72 offen nt
  s_add_u32 s72, s72, 0x8000
  v_and_b32_dpp v24, v156, v6 row_newbcast:12 row_mask:0xf bank_mask:0xf
  v_and_b32_dpp v25, v156, v7 row_newbcast:12 row_mask:0xf bank_mask:0xf
  v_and_b32_dpp v26, v156, v8 row_newbcast:12 row_mask:0xf bank_mask:0xf
  v_and_b32_dpp v27, v156, v9 row_newbcast:12 row_mask:0xf bank_mask:0xf
  s_waitcnt vmcnt(23)
  s_nop 0
  v_mfma_f32_16x16x32_bf16 v[20:23], v[24:27], v[92:95], v[20:23]
  v_and_b32_dpp v28, v156, v6 row_newbcast:13 row_mask:0xf bank_mask:0xf
  v_and_b32_dpp v29, v156, v7 row_newbcast:13 row_mask:0xf bank_mask:0xf
  v_and_b32_dpp v30, v156, v8 row_newbcast:13 row_mask:0xf bank_mask:0xf
  v_and_b32_dpp v31, v156, v9 row_newbcast:13 row_mask:0xf bank_mask:0xf
  s_waitcnt vmcnt(22)
  s_nop 0
  v_mfma_f32_16x16x32_bf16 v[20:23], v[28:31], v[96:99], v[20:23]
  v_and_b32_dpp v24, v156, v6 row_newbcast:14 row_mask:0xf bank_mask:0xf
  v_and_b32_dpp v25, v156, v7 row_newbcast:14 row_mask:0xf bank_mask:0xf
  v_and_b32_dpp v26, v156, v8 row_newbcast:14 row_mask:0xf bank_mask:0xf
  v_and_b32_dpp v27, v156, v9 row_newbcast:14 row_mask:0xf bank_mask:0xf
  s_waitcnt vmcnt(21)
  s_nop 0
  v_mfma_f32_16x16x32_bf16 v[20:23], v[24:27], v[100:103], v[20:23]
  v_and_b32_dpp v28, v156, v6 row_newbcast:15 row_mask:0xf bank_mask:0xf
  v_and_b32_dpp v29, v156, v7 row_newbcast:15 row_mask:0xf bank_mask:0xf
  v_and_b32_dpp v30, v156, v8 row_newbcast:15 row_mask:0xf bank_mask:0xf
  v_and_b32_dpp v31, v156, v9 row_newbcast:15 row_mask:0xf bank_mask:0xf
  s_waitcnt vmcnt(20)
  s_nop 0
  v_mfma_f32_16x16x32_bf16 v[20:23], v[28:31], v[104:107], v[20:23]
  v_and_b32_dpp v24, v157, v6 row_newbcast:0 row_mask:0xf bank_mask:0xf
  v_and_b32_dpp v25, v157, v7 row_newbcast:0 row_mask:0xf bank_mask:0xf
  v_and_b32_dpp v26, v157, v8 row_newbcast:0 row_mask:0xf bank_mask:0xf
  v_and_b32_dpp v27, v157, v9 row_newbcast:0 row_mask:0xf bank_mask:0xf
  s_waitcnt vmcnt(19)
  s_nop 0
  v_mfma_f32_16x16x32_bf16 v[20:23], v[24:27], v[108:111], v[20:23]
  v_and_b32_dpp v28, v157, v6 row_newbcast:1 row_mask:0xf bank_mask:0xf
  v_and_b32_dpp v29, v157, v7 row_newbcast:1 row_mask:0xf bank_mask:0xf
  v_and_b32_dpp v30, v157, v8 row_newbcast:1 row_mask:0xf bank_mask:0xf
  v_and_b32_dpp v31, v157, v9 row_newbcast:1 row_mask:0xf bank_mask:0xf
  s_waitcnt vmcnt(18)
  s_nop 0
  v_mfma_f32_16x16x32_bf16 v[20:23], v[28:31], v[112:115], v[20:23]
  v_and_b32_dpp v24, v158, v6 row_newbcast:0 row_mask:0xf bank_mask:0xf
  v_and_b32_dpp v25, v158, v7 row_newbcast:0 row_mask:0xf bank_mask:0xf
  v_and_b32_dpp v26, v158, v8 row_newbcast:0 row_mask:0xf bank_mask:0xf
  v_and_b32_dpp v27, v158, v9 row_newbcast:0 row_mask:0xf bank_mask:0xf
  s_waitcnt vmcnt(17)
  s_nop 0
  v_mfma_f32_16x16x32_bf16 v[20:23], v[24:27], v[116:119], v[20:23]
  v_and_b32_dpp v28, v158, v6 row_newbcast:1 row_mask:0xf bank_mask:0xf
  v_and_b32_dpp v29, v158, v7 row_newbcast:1 row_mask:0xf bank_mask:0xf
  v_and_b32_dpp v30, v158, v8 row_newbcast:1 row_mask:0xf bank_mask:0xf
  v_and_b32_dpp v31, v158, v9 row_newbcast:1 row_mask:0xf bank_mask:0xf
  s_waitcnt vmcnt(16)
  s_nop 0
  v_mfma_f32_16x16x32_bf16 v[20:23], v[28:31], v[120:123], v[20:23]
  v_and_b32_dpp v24, v158, v6 row_newbcast:2 row_mask:0xf bank_mask:0xf
  v_and_b32_dpp v25, v158, v7 row_newbcast:2 row_mask:0xf bank_mask:0xf
  v_and_b32_dpp v26, v158, v8 row_newbcast:2 row_mask:0xf bank_mask:0xf
  v_and_b32_dpp v27, v158, v9 row_newbcast:2 row_mask:0xf bank_mask:0xf
  s_waitcnt vmcnt(15)
  s_nop 0
  v_mfma_f32_16x16x32_bf16 v[20:23], v[24:27], v[124:127], v[20:23]
  v_and_b32_dpp v28, v158, v6 row_newbcast:3 row_mask:0xf bank_mask:0xf
  v_and_b32_dpp v29, v158, v7 row_newbcast:3 row_mask:0xf bank_mask:0xf
  v_and_b32_dpp v30, v158, v8 row_newbcast:3 row_mask:0xf bank_mask:0xf
  v_and_b32_dpp v31, v158, v9 row_newbcast:3 row_mask:0xf bank_mask:0xf
  s_waitcnt vmcnt(14)
  s_nop 0
  v_mfma_f32_16x16x32_bf16 v[20:23], v[28:31], v[128:131], v[20:23]
  v_and_b32_dpp v24, v158, v6 row_newbcast:4 row_mask:0xf bank_mask:0xf
  v_and_b32_dpp v25, v158, v7 row_newbcast:4 row_mask:0xf bank_mask:0xf
  v_and_b32_dpp v26, v158, v8 row_newbcast:4 row_mask:0xf bank_mask:0xf
  v_and_b32_dpp v27, v158, v9 row_newbcast:4 row_mask:0xf bank_mask:0xf
  s_waitcnt vmcnt(13)
  s_nop 0
  v_mfma_f32_16x16x32_bf16 v[20:23], v[24:27], v[132:135], v[20:23]
  v_and_b32_dpp v28, v158, v6 row_newbcast:5 row_mask:0xf bank_mask:0xf
  v_and_b32_dpp v29, v158, v7 row_newbcast:5 row_mask:0xf bank_mask:0xf
  v_and_b32_dpp v30, v158, v8 row_newbcast:5 row_mask:0xf bank_mask:0xf
  v_and_b32_dpp v31, v158, v9 row_newbcast:5 row_mask:0xf bank_mask:0xf
  s_waitcnt vmcnt(12)
  s_nop 0
  v_mfma_f32_16x16x32_bf16 v[20:23], v[28:31], v[136:139], v[20:23]
  v_and_b32_dpp v24, v158, v6 row_newbcast:6 row_mask:0xf bank_mask:0xf
  v_and_b32_dpp v25, v158, v7 row_newbcast:6 row_mask:0xf bank_mask:0xf
  v_and_b32_dpp v26, v158, v8 row_newbcast:6 row_mask:0xf bank_mask:0xf
  v_and_b32_dpp v27, v158, v9 row_newbcast:6 row_mask:0xf bank_mask:0xf
  s_waitcnt vmcnt(11)
  s_nop 0
  v_mfma_f32_16x16x32_bf16 v[20:23], v[24:27], v[44:47], v[20:23]
  v_and_b32_dpp v28, v158, v6 row_newbcast:7 row_mask:0xf bank_mask:0xf
  v_and_b32_dpp v29, v158, v7 row_newbcast:7 row_mask:0xf bank_mask:0xf
  v_and_b32_dpp v30, v158, v8 row_newbcast:7 row_mask:0xf bank_mask:0xf
  v_and_b32_dpp v31, v158, v9 row_newbcast:7 row_mask:0xf bank_mask:0xf
  s_waitcnt vmcnt(10)
  s_nop 0
  v_mfma_f32_16x16x32_bf16 v[20:23], v[28:31], v[48:51], v[20:23]
  v_and_b32_dpp v24, v158, v6 row_newbcast:8 row_mask:0xf bank_mask:0xf
  v_and_b32_dpp v25, v158, v7 row_newbcast:8 row_mask:0xf bank_mask:0xf
  v_and_b32_dpp v26, v158, v8 row_newbcast:8 row_mask:0xf bank_mask:0xf
  v_and_b32_dpp v27, v158, v9 row_newbcast:8 row_mask:0xf bank_mask:0xf
  s_waitcnt vmcnt(9)
  s_nop 0
  v_mfma_f32_16x16x32_bf16 v[20:23], v[24:27], v[52:55], v[20:23]
  v_and_b32_dpp v28, v158, v6 row_newbcast:9 row_mask:0xf bank_mask:0xf
  v_and_b32_dpp v29, v158, v7 row_newbcast:9 row_mask:0xf bank_mask:0xf
  v_and_b32_dpp v30, v158, v8 row_newbcast:9 row_mask:0xf bank_mask:0xf
  v_and_b32_dpp v31, v158, v9 row_newbcast:9 row_mask:0xf bank_mask:0xf
  s_waitcnt vmcnt(8)
  s_nop 0
  v_mfma_f32_16x16x32_bf16 v[20:23], v[28:31], v[56:59], v[20:23]
  v_and_b32_dpp v24, v158, v6 row_newbcast:10 row_mask:0xf bank_mask:0xf
  v_and_b32_dpp v25, v158, v7 row_newbcast:10 row_mask:0xf bank_mask:0xf
  v_and_b32_dpp v26, v158, v8 row_newbcast:10 row_mask:0xf bank_mask:0xf
  v_and_b32_dpp v27, v158, v9 row_newbcast:10 row_mask:0xf bank_mask:0xf
  s_waitcnt vmcnt(7)
  s_nop 0
  v_mfma_f32_16x16x32_bf16 v[20:23], v[24:27], v[60:63], v[20:23]
  v_and_b32_dpp v28, v158, v6 row_newbcast:11 row_mask:0xf bank_mask:0xf
  v_and_b32_dpp v29, v158, v7 row_newbcast:11 row_mask:0xf bank_mask:0xf
  v_and_b32_dpp v30, v158, v8 row_newbcast:11 row_mask:0xf bank_mask:0xf
  v_and_b32_dpp v31, v158, v9 row_newbcast:11 row_mask:0xf bank_mask:0xf
  s_waitcnt vmcnt(6)
  s_nop 0
  v_mfma_f32_16x16x32_bf16 v[20:23], v[28:31], v[64:67], v[20:23]
  v_and_b32_dpp v24, v158, v6 row_newbcast:12 row_mask:0xf bank_mask:0xf
  v_and_b32_dpp v25, v158, v7 row_newbcast:12 row_mask:0xf bank_mask:0xf
  v_and_b32_dpp v26, v158, v8 row_newbcast:12 row_mask:0xf bank_mask:0xf
  v_and_b32_dpp v27, v158, v9 row_newbcast:12 row_mask:0xf bank_mask:0xf
  s_waitcnt vmcnt(5)
  s_nop 0
  v_mfma_f32_16x16x32_bf16 v[20:23], v[24:27], v[68:71], v[20:23]
  v_and_b32_dpp v28, v158, v6 row_newbcast:13 row_mask:0xf bank_mask:0xf
  v_and_b32_dpp v29, v158, v7 row_newbcast:13 row_mask:0xf bank_mask:0xf
  v_and_b32_dpp v30, v158, v8 row_newbcast:13 row_mask:0xf bank_mask:0xf
  v_and_b32_dpp v31, v158, v9 row_newbcast:13 row_mask:0xf bank_mask:0xf
  s_waitcnt vmcnt(4)
  s_nop 0
  v_mfma_f32_16x16x32_bf16 v[20:23], v[28:31], v[72:75], v[20:23]
  v_and_b32_dpp v24, v158, v6 row_newbcast:14 row_mask:0xf bank_mask:0xf
  v_and_b32_dpp v25, v158, v7 row_newbcast:14 row_mask:0xf bank_mask:0xf
  v_and_b32_dpp v26, v158, v8 row_newbcast:14 row_mask:0xf bank_mask:0xf
  v_and_b32_dpp v27, v158, v9 row_newbcast:14 row_mask:0xf bank_mask:0xf
  s_waitcnt vmcnt(3)
  s_nop 0
  v_mfma_f32_16x16x32_bf16 v[20:23], v[24:27], v[76:79], v[20:23]
  v_and_b32_dpp v28, v158, v6 row_newbcast:15 row_mask:0xf bank_mask:0xf
  v_and_b32_dpp v29, v158, v7 row_newbcast:15 row_mask:0xf bank_mask:0xf
  v_and_b32_dpp v30, v158, v8 row_newbcast:15 row_mask:0xf bank_mask:0xf
  v_and_b32_dpp v31, v158, v9 row_newbcast:15 row_mask:0xf bank_mask:0xf
  s_waitcnt vmcnt(2)
  s_nop 0
  v_mfma_f32_16x16x32_bf16 v[20:23], v[28:31], v[80:83], v[20:23]
  v_and_b32_dpp v24, v159, v6 row_newbcast:0 row_mask:0xf bank_mask:0xf
  v_and_b32_dpp v25, v159, v7 row_newbcast:0 row_mask:0xf bank_mask:0xf
  v_and_b32_dpp v26, v159, v8 row_newbcast:0 row_mask:0xf bank_mask:0xf
  v_and_b32_dpp v27, v159, v9 row_newbcast:0 row_mask:0xf bank_mask:0xf
  s_waitcnt vmcnt(1)
  s_nop 0
  v_mfma_f32_16x16x32_bf16 v[20:23], v[24:27], v[84:87], v[20:23]
  v_and_b32_dpp v28, v159, v6 row_newbcast:1 row_mask:0xf bank_mask:0xf
  v_and_b32_dpp v29, v159, v7 row_newbcast:1 row_mask:0xf bank_mask:0xf
  v_and_b32_dpp v30, v159, v8 row_newbcast:1 row_mask:0xf bank_mask:0xf
  v_and_b32_dpp v31, v159, v9 row_newbcast:1 row_mask:0xf bank_mask:0xf
  s_waitcnt vmcnt(0)
  s_nop 0
  v_mfma_f32_16x16x32_bf16 v[20:23], v[28:31], v[88:91], v[20:23]
  s_waitcnt lgkmcnt(0)
  s_add_u32 s75, s75, 1
  s_and_b32 s88, s75, 255
  s_movk_i32 s89, 0xff
  v_mov_b32 v25, s75
  s_lshl_b32 s77, s67, 1
  s_add_u32 s77, s77, s66
  s_lshl_b32 s77, s77, 12
  s_add_u32 s77, s77, 1179648
  v_lshlrev_b32 v34, 5, v3
  v_and_b32 v35, 1, v2
  v_lshl_add_u32 v34, v35, 4, v34
  s_lshr_b32 s76, s74, 1
  s_lshl_b32 s76, s76, 9
  s_add_u32 s76, s76, s77
  v_add_u32 v20, 0x80, v20
  v_add_u32 v21, 0x80, v21
  v_add_u32 v22, 0x80, v22
  v_add_u32 v23, 0x80, v23
  v_bfi_b32 v20, s89, v25, v20
  v_bfi_b32 v21, s89, v25, v21
  v_bfi_b32 v22, s89, v25, v22
  v_bfi_b32 v23, s89, v25, v23
  s_mov_b32 exec_hi, 0
  buffer_store_dwordx4 v[20:23], v34, s[52:55], s76 offen sc1
  s_mov_b32 exec_hi, -1
  s_mov_b32 s87, 0
  v_and_b32 v35, 31, v1
  v_lshlrev_b32 v35, 3, v35
  v_lshrrev_b32 v34, 5, v1
  v_lshl_add_u32 v35, v34, 2, v35
L_qp:
  s_sleep 20
  buffer_load_dwordx4 v[44:47], v33, s[52:55], s77 offen offset:0 sc1
  buffer_load_dwordx4 v[48:51], v33, s[52:55], s77 offen offset:1024 sc1
  s_waitcnt vmcnt(0)
  v_xor_b32 v44, s88, v44
  v_xor_b32 v45, s88, v45
  v_xor_b32 v46, s88, v46
  v_xor_b32 v47, s88, v47
  v_xor_b32 v48, s88, v48
  v_xor_b32 v49, s88, v49
  v_xor_b32 v50, s88, v50
  v_xor_b32 v51, s88, v51
  v_or_b32 v36, v44, v45
  v_or3_b32 v36, v36, v46, v47
  v_or3_b32 v36, v36, v48, v49
  v_or3_b32 v36, v36, v50, v51
  v_cmp_ne_u32_sdwa vcc, v36, v5 src0_sel:BYTE_0 src1_sel:DWORD
  s_nop 3
  s_cbranch_vccz L_qp_ok
  s_add_u32 s87, s87, 1
  s_cmp_lt_u32 s87, 20000
  s_cbranch_scc1 L_qp
L_qp_ok:
  v_pk_add_f32 v[44:45], v[44:45], v[48:49]
  v_pk_add_f32 v[46:47], v[46:47], v[50:51]
  s_nop 1
  v_permlane32_swap_b32 v44, v46
  v_permlane32_swap_b32 v45, v47
  v_pk_add_f32 v[44:45], v[44:45], v[46:47]
  v_cvt_pk_bf16_f32 v44, v44, v45
  ds_write_b32 v35, v44 offset:0
  s_setprio 0
  s_lshl_b32 s76, s65, 8
  s_add_u32 s76, s76, 65536
  s_mov_b64 exec, 0xffff
  buffer_store_dwordx4 v[144:147], v33, s[52:55], s76 offen sc1
  s_cmp_ge_u32 s65, 72
  s_cbranch_scc1 L_nys
  s_add_u32 s76, s76, 65536
  buffer_store_dwordx4 v[144:147], v33, s[52:55], s76 offen sc1
L_nys:
  s_mov_b64 exec, -1
  s_waitcnt vmcnt(0)
  v_mov_b32 v128, v33
  v_and_b32 v36, 7, v1
  v_lshlrev_b32 v36, 3, v36
  v_lshrrev_b32 v129, 3, v1
  v_mul_u32_u24 v129, 4352, v129
  v_add_u32 v129, v36, v129
  s_mov_b32 s87, 0
L_ml:
  ds_read_b64 v[32:33], v36 offset:256
  s_memrealtime s[98:99]
  s_waitcnt lgkmcnt(0)
  v_cmp_u_f32 vcc, v33, v33
  s_nop 3
  s_cbranch_vccz L_ml_ok
  s_sleep 8
  s_add_u32 s87, s87, 1
  s_cmp_lt_u32 s87, 80000
  s_cbranch_scc1 L_ml
L_ml_ok:
  v_max_f32_dpp v34, v32, v32 row_ror:4 row_mask:0xf bank_mask:0xf
  s_nop 1
  v_max_f32_dpp v34, v34, v34 row_ror:2 row_mask:0xf bank_mask:0xf
  s_nop 1
  v_max_f32_dpp v34, v34, v34 row_ror:1 row_mask:0xf bank_mask:0xf
  v_sub_f32 v35, v32, v34
  v_exp_f32 v35, v35
  s_nop 0
  v_mul_f32 v33, v35, v33
  s_nop 1
  v_add_f32_dpp v33, v33, v33 row_ror:4 row_mask:0xf bank_mask:0xf
  s_nop 1
  v_add_f32_dpp v33, v33, v33 row_ror:2 row_mask:0xf bank_mask:0xf
  s_nop 1
  v_add_f32_dpp v33, v33, v33 row_ror:1 row_mask:0xf bank_mask:0xf
  v_log_f32 v33, v33
  s_lshr_b32 s50, s65, 2
  s_lshl_b32 s50, s50, 7
  s_add_u32 s50, s50, 8192
  s_and_b32 s77, s65, 3
  s_lshl_b32 s77, s77, 3
  s_add_u32 s77, s77, s50
  v_add_f32 v24, v33, v34
  v_and_b32 v37, 24, v36
  s_mov_b64 exec, 1
  buffer_store_dwordx2 v[24:25], v5, s[52:55], s77 offen sc1
  s_mov_b64 exec, -1
  s_mov_b32 s87, 0
  s_mov_b32 s89, s50
  v_and_b32 v130, 31, v1
  v_lshlrev_b32 v130, 3, v130
  v_lshrrev_b32 v129, 5, v1
  v_mul_u32_u24 v129, 4352, v129
  v_add_u32 v129, v130, v129
  s_mul_i32 s50, s69, 4352
  s_add_u32 s50, s50, 16384
  s_lshl_b32 s51, s68, 3
  s_add_u32 s51, s51, s50
  s_mov_b32 s87, 0
L_pm:
  ds_read_b32 v34, v5 offset:364
  s_memrealtime s[98:99]
  s_waitcnt lgkmcnt(0)
  v_readfirstlane_b32 s76, v34
  s_cmp_ge_i32 s76, 255
  s_nop 2
  s_cbranch_scc1 L_pm_ok
  s_sleep 8
  s_add_u32 s87, s87, 1
  s_cmp_lt_u32 s87, 400000
  s_cbranch_scc1 L_pm
L_pm_ok:
  s_lshl_b32 s98, s98, 8
  s_add_u32 s98, s98, s2
  v_mov_b32 v24, s98
  s_mov_b64 exec, 1
  buffer_store_dwordx2 v[24:25], v5, s[52:55], s51 offen offset:0 sc1
  s_mov_b64 exec, -1
  s_mov_b32 s87, 0
L_pc:
  ds_read_b32 v34, v5 offset:364
  s_waitcnt lgkmcnt(0)
  v_readfirstlane_b32 s76, v34
  s_cmp_ge_i32 s76, 65535
  s_nop 2
  s_cbranch_scc1 L_pc_ok
  s_sleep 8
  s_add_u32 s87, s87, 1
  s_cmp_lt_u32 s87, 400000
  s_cbranch_scc1 L_pc
L_pc_ok:
  s_mov_b32 s87, 0
  s_mov_b32 s80, 16384
  s_mov_b32 s81, 25088
  s_mov_b32 s82, 33792
  s_mov_b32 s83, 42496
L_al:
  buffer_load_dwordx2 v[44:45], v129, s[52:55], s80 offen sc1
  buffer_load_dwordx2 v[46:47], v129, s[52:55], s81 offen sc1
  buffer_load_dwordx2 v[48:49], v129, s[52:55], s82 offen sc1
  buffer_load_dwordx2 v[50:51], v129, s[52:55], s83 offen sc1
  buffer_load_dwordx2 v[52:53], v130, s[52:55], s50 offen sc1
  buffer_load_dwordx2 v[34:35], v37, s[52:55], s89 offen sc1
  s_waitcnt vmcnt(0)
  v_xor_b32 v45, s75, v45
  v_xor_b32 v47, s75, v47
  v_xor_b32 v49, s75, v49
  v_xor_b32 v51, s75, v51
  v_xor_b32 v53, s75, v53
  v_xor_b32 v35, s75, v35
  v_or_b32 v45, v45, v35
  v_or3_b32 v35, v45, v47, v49
  v_or3_b32 v35, v35, v51, v53
  v_cmp_ne_u32 vcc, 0, v35
  s_nop 3
  s_cbranch_vccz L_al_ok
  s_sleep 40
  s_add_u32 s87, s87, 1
  s_cmp_lt_u32 s87, 20000
  s_cbranch_scc1 L_al
L_al_ok:
  v_max_f32_dpp v35, v34, v34 quad_perm:[1,0,3,2] row_mask:0xf bank_mask:0xf
  s_nop 1
  v_max_f32_dpp v35, v35, v35 quad_perm:[2,3,0,1] row_mask:0xf bank_mask:0xf
  v_sub_f32 v34, v34, v35
  v_exp_f32 v34, v34
  v_sub_f32 v32, v32, v35
  v_exp_f32 v32, v32
  v_add_f32_dpp v34, v34, v34 quad_perm:[1,0,3,2] row_mask:0xf bank_mask:0xf
  s_nop 1
  v_add_f32_dpp v34, v34, v34 quad_perm:[2,3,0,1] row_mask:0xf bank_mask:0xf
  v_rcp_f32 v34, v34
  v_lshrrev_b32 v36, 1, v36
  v_mul_f32 v32, v32, v34
  s_mov_b64 exec, 0xff
  ds_write_b32 v36, v32 offset:320
  s_mov_b64 exec, -1
  s_cmp_lg_u32 s2, 0
  s_cbranch_scc1 L_noep
  s_mov_b64 exec, 1
  buffer_store_dword v25, v5, s[52:55], 0 offen offset:0 sc1
  s_mov_b64 exec, -1
L_noep:
  v_cmp_gt_u32 vcc, s98, v52
  s_bcnt1_i32_b32 s51, vcc_lo
  v_cmp_lt_u32 vcc, s98, v52
  s_nop 1
  v_cndmask_b32 v34, -1, v52, vcc
  s_nop 1
  v_min_u32_dpp v34, v34, v34 row_ror:8 row_mask:0xf bank_mask:0xf
  s_nop 1
  v_min_u32_dpp v34, v34, v34 row_ror:4 row_mask:0xf bank_mask:0xf
  s_nop 1
  v_min_u32_dpp v34, v34, v34 row_ror:2 row_mask:0xf bank_mask:0xf
  s_nop 1
  v_min_u32_dpp v34, v34, v34 row_ror:1 row_mask:0xf bank_mask:0xf
  v_mov_b32 v35, v34
  s_nop 1
  v_permlane16_swap_b32 v34, v35
  v_min_u32 v34, v34, v35
  s_nop 0
  v_readfirstlane_b32 s76, v34
  s_and_b32 s96, s51, 1
  s_cselect_b32 s76, s98, s76
  v_cmp_gt_u32 s[80:81], s76, v44
  v_cmp_gt_u32 s[82:83], s76, v46
  s_bcnt1_i32_b32 s77, s80
  s_andn2_b32 s77, s77, 1
  s_add_u32 s96, s96, s77
  s_bcnt1_i32_b32 s77, s81
  s_andn2_b32 s77, s77, 1
  s_add_u32 s96, s96, s77
  s_bcnt1_i32_b32 s77, s82
  s_andn2_b32 s77, s77, 1
  s_add_u32 s96, s96, s77
  s_bcnt1_i32_b32 s77, s83
  s_andn2_b32 s77, s77, 1
  s_add_u32 s96, s96, s77
  v_cmp_gt_u32 s[80:81], s76, v48
  v_cmp_gt_u32 s[82:83], s76, v50
  s_bcnt1_i32_b32 s77, s80
  s_andn2_b32 s77, s77, 1
  s_add_u32 s96, s96, s77
  s_bcnt1_i32_b32 s77, s81
  s_andn2_b32 s77, s77, 1
  s_add_u32 s96, s96, s77
  s_bcnt1_i32_b32 s77, s82
  s_andn2_b32 s77, s77, 1
  s_add_u32 s96, s96, s77
  s_bcnt1_i32_b32 s77, s83
  s_andn2_b32 s77, s77, 1
  s_add_u32 s96, s96, s77
  s_and_b32 s96, s96, 255
  s_sub_u32 s76, s96, 18
  s_mul_i32 s77, s76, 147
  s_lshr_b32 s77, s77, 11
  s_mul_i32 s97, s77, 14
  s_sub_u32 s76, s76, s97
  s_cmp_ge_u32 s76, 6
  s_cselect_b32 s97, 2, 0
  s_add_u32 s76, s76, s97
  s_lshl_b32 s77, s77, 4
  s_add_u32 s76, s76, s77
  s_lshr_b32 s77, s96, 1
  s_lshl_b32 s77, s77, 4
  s_and_b32 s97, s96, 1
  s_add_u32 s77, s77, s97
  s_add_u32 s77, s77, 6
  s_cmp_lt_u32 s96, 18
  s_cselect_b32 s76, s77, s76
  s_cmp_lt_u32 s96, 144
  s_cselect_b32 s100, s76, s96
  s_and_b32 s75, s75, 255
  s_movk_i32 s74, 0xff
  s_lshl_b32 s76, s75, 16
  s_or_b32 s76, s76, s100
  v_mov_b32 v34, s76
  ds_write_b32 v5, v34 offset:360
  s_cmp_lt_u32 s100, 216
  s_cbranch_scc0 L_fin
  s_mov_b32 s44, s20
  s_mov_b32 s45, s21
  s_mov_b32 s46, 5308416
  s_mov_b32 s47, 0x20000
  s_mov_b32 m0, 16384
  s_mov_b32 s79, 0
  s_mov_b32 s87, 0
  s_cmp_lt_u32 s100, 144
  s_cbranch_scc1 L_hf2
  s_mov_b32 s36, s12
  s_mov_b32 s37, s13
  s_mov_b32 s38, 4718592
  s_mov_b32 s39, 0x20000
  s_mov_b32 s40, s12
  s_mov_b32 s41, s13
  s_mov_b32 s42, 4718592
  s_mov_b32 s43, 0x20000
  s_sub_u32 s101, s100, 144
  s_and_b32 s90, s101, 7
  s_lshr_b32 s77, s101, 3
  s_mul_i32 s72, s90, 589824
  s_lshl_b32 s77, s77, 7
  s_add_u32 s72, s72, s77
  s_add_u32 s73, s72, 9216
  s_mov_b32 s78, 18432
  s_mov_b32 s71, 32
  s_mov_b32 s88, 0xff00
  s_mov_b32 s89, 2048
  v_lshrrev_b32 v34, 3, v1
  v_mul_u32_u24 v34, 1152, v34
  v_and_b32 v35, 1, v2
  v_lshlrev_b32 v35, 1, v35
  v_and_b32 v36, 7, v1
  v_xor_b32 v35, v35, v36
  v_lshl_add_u32 v38, v35, 4, v34
  v_xor_b32 v35, 4, v35
  v_lshl_add_u32 v39, v35, 4, v34
  s_nop 0
  s_branch L_is
L_hf2:
  s_mov_b32 s36, s16
  s_mov_b32 s37, s17
  s_mov_b32 s38, 5308416
  s_mov_b32 s39, 0x20000
  s_mov_b32 s40, s18
  s_mov_b32 s41, s19
  s_mov_b32 s42, 5308416
  s_mov_b32 s43, 0x20000
  s_lshl_b32 s72, s100, 6
  s_mov_b32 s50, s72
  s_and_b32 s76, s100, 0
  s_mul_i32 s77, s76, 2654208
  s_add_u32 s72, s72, s77
  s_mul_i32 s77, s76, 36864
  s_add_u32 m0, m0, s77
  s_mov_b32 s73, s72
  s_mov_b32 s78, 147456
  s_mov_b32 s71, 36
  s_mov_b32 s88, 255
  s_mov_b32 s89, 8
  s_mul_i32 s70, s100, 36864
  v_lshrrev_b32 v34, 2, v1
  v_mul_u32_u24 v34, 9216, v34
  v_lshrrev_b32 v35, 5, v1
  v_lshlrev_b32 v35, 1, v35
  v_and_b32 v36, 3, v1
  v_xor_b32 v35, v35, v36
  v_lshl_add_u32 v38, v35, 4, v34
  v_mov_b32 v39, v38
  v_lshrrev_b32 v34, 3, v1
  v_mul_u32_u24 v34, 1152, v34
  v_and_b32 v35, 1, v2
  v_lshlrev_b32 v35, 1, v35
  v_and_b32 v36, 7, v1
  v_xor_b32 v35, v35, v36
  v_lshl_add_u32 v42, v35, 4, v34
  v_xor_b32 v43, 64, v42
  s_nop 1
L_is:
  ds_read_b32 v34, v5 offset:352
  s_waitcnt lgkmcnt(0)
  v_readfirstlane_b32 s76, v34
  s_add_u32 s76, s76, 1
  s_and_b32 s76, s76, s88
  s_cmp_ge_u32 s76, s89
  s_nop 0
  s_cbranch_scc1 L_is_ok
  s_sleep 8
  s_add_u32 s87, s87, 1
  s_cmp_lt_u32 s87, 400000
  s_cbranch_scc1 L_is
L_is_ok:
  s_cmp_ge_u32 s79, 16
  s_cbranch_scc1 L_d1
L_d0:
  s_waitcnt vmcnt(60)
  buffer_load_dwordx4 v38, s[36:39], s72 offen nt lds
  s_add_u32 m0, m0, 1024
  s_add_u32 s72, s72, s78
  s_waitcnt vmcnt(60)
  buffer_load_dwordx4 v39, s[40:43], s73 offen nt lds
  s_add_u32 m0, m0, 1024
  s_add_u32 s73, s73, s78
  s_add_u32 s79, s79, 1
  s_cmp_lt_u32 s79, 16
  s_cbranch_scc1 L_d0
L_d1:
  s_cmp_ge_u32 s79, s71
  s_cbranch_scc1 L_d3
  ds_read_b32 v34, v5 offset:356
  s_waitcnt vmcnt(31)
  buffer_load_dwordx4 v38, s[36:39], s72 offen nt lds
  s_add_u32 m0, m0, 1024
  s_add_u32 s72, s72, s78
  s_waitcnt vmcnt(31)
  buffer_load_dwordx4 v39, s[40:43], s73 offen nt lds
  s_add_u32 m0, m0, 1024
  s_add_u32 s73, s73, s78
  s_add_u32 s79, s79, 1
  s_waitcnt lgkmcnt(0)
  v_readfirstlane_b32 s76, v34
  s_cmp_lt_i32 s76, 8
  s_nop 2
  s_cbranch_scc1 L_d1
L_d2:
  s_cmp_ge_u32 s79, s71
  s_cbranch_scc1 L_d3
  s_waitcnt vmcnt(60)
  buffer_load_dwordx4 v38, s[36:39], s72 offen nt lds
  s_add_u32 m0, m0, 1024
  s_add_u32 s72, s72, s78
  s_waitcnt vmcnt(60)
  buffer_load_dwordx4 v39, s[40:43], s73 offen nt lds
  s_add_u32 m0, m0, 1024
  s_add_u32 s73, s73, s78
  s_add_u32 s79, s79, 1
  s_branch L_d2
L_d3:
  s_mov_b32 m0, 90112
  s_cmp_lt_u32 s100, 144
  s_cbranch_scc0 L_red
  s_movk_i32 s98, 3968
  s_waitcnt vmcnt(60)
  buffer_load_dwordx4 v42, s[44:47], s70 offen offset:0 nt lds
  s_add_u32 m0, m0, s98
  s_waitcnt vmcnt(60)
  buffer_load_dwordx4 v42, s[44:47], s70 offen offset:128 nt lds
  s_add_u32 m0, m0, s98
  s_waitcnt vmcnt(60)
  buffer_load_dwordx4 v42, s[44:47], s70 offen offset:256 nt lds
  s_add_u32 m0, m0, s98
  s_waitcnt vmcnt(60)
  buffer_load_dwordx4 v42, s[44:47], s70 offen offset:384 nt lds
  s_add_u32 m0, m0, s98
  s_waitcnt vmcnt(60)
  buffer_load_dwordx4 v42, s[44:47], s70 offen offset:512 nt lds
  s_add_u32 m0, m0, s98
  s_waitcnt vmcnt(60)
  buffer_load_dwordx4 v42, s[44:47], s70 offen offset:640 nt lds
  s_add_u32 m0, m0, s98
  s_waitcnt vmcnt(60)
  buffer_load_dwordx4 v42, s[44:47], s70 offen offset:768 nt lds
  s_add_u32 m0, m0, s98
  s_waitcnt vmcnt(60)
  buffer_load_dwordx4 v42, s[44:47], s70 offen offset:896 nt lds
  s_add_u32 m0, m0, s98
  s_waitcnt vmcnt(60)
  buffer_load_dwordx4 v42, s[44:47], s70 offen offset:1024 nt lds
  s_mov_b32 m0, 91136
  s_add_u32 s70, s70, 9216
  s_waitcnt vmcnt(60)
  buffer_load_dwordx4 v43, s[44:47], s70 offen offset:0 nt lds
  s_add_u32 m0, m0, s98
  s_waitcnt vmcnt(60)
  buffer_load_dwordx4 v43, s[44:47], s70 offen offset:128 nt lds
  s_add_u32 m0, m0, s98
  s_waitcnt vmcnt(60)
  buffer_load_dwordx4 v43, s[44:47], s70 offen offset:256 nt lds
  s_add_u32 m0, m0, s98
  s_waitcnt vmcnt(60)
  buffer_load_dwordx4 v43, s[44:47], s70 offen offset:384 nt lds
  s_add_u32 m0, m0, s98
  s_waitcnt vmcnt(60)
  buffer_load_dwordx4 v43, s[44:47], s70 offen offset:512 nt lds
  s_add_u32 m0, m0, s98
  s_waitcnt vmcnt(60)
  buffer_load_dwordx4 v43, s[44:47], s70 offen offset:640 nt lds
  s_add_u32 m0, m0, s98
  s_waitcnt vmcnt(60)
  buffer_load_dwordx4 v43, s[44:47], s70 offen offset:768 nt lds
  s_add_u32 m0, m0, s98
  s_waitcnt vmcnt(60)
  buffer_load_dwordx4 v43, s[44:47], s70 offen offset:896 nt lds
  s_add_u32 m0, m0, s98
  s_waitcnt vmcnt(60)
  buffer_load_dwordx4 v43, s[44:47], s70 offen offset:1024 nt lds
  s_mov_b32 m0, 92160
  s_add_u32 s70, s70, 9216
  s_waitcnt vmcnt(60)
  buffer_load_dwordx4 v42, s[44:47], s70 offen offset:0 nt lds
  s_add_u32 m0, m0, s98
  s_waitcnt vmcnt(60)
  buffer_load_dwordx4 v42, s[44:47], s70 offen offset:128 nt lds
  s_add_u32 m0, m0, s98
  s_waitcnt vmcnt(60)
  buffer_load_dwordx4 v42, s[44:47], s70 offen offset:256 nt lds
  s_add_u32 m0, m0, s98
  s_waitcnt vmcnt(60)
  buffer_load_dwordx4 v42, s[44:47], s70 offen offset:384 nt lds
  s_add_u32 m0, m0, s98
  s_waitcnt vmcnt(60)
  buffer_load_dwordx4 v42, s[44:47], s70 offen offset:512 nt lds
  s_add_u32 m0, m0, s98
  s_waitcnt vmcnt(60)
  buffer_load_dwordx4 v42, s[44:47], s70 offen offset:640 nt lds
  s_add_u32 m0, m0, s98
  s_waitcnt vmcnt(60)
  buffer_load_dwordx4 v42, s[44:47], s70 offen offset:768 nt lds
  s_add_u32 m0, m0, s98
  s_waitcnt vmcnt(60)
  buffer_load_dwordx4 v42, s[44:47], s70 offen offset:896 nt lds
  s_add_u32 m0, m0, s98
  s_waitcnt vmcnt(60)
  buffer_load_dwordx4 v42, s[44:47], s70 offen offset:1024 nt lds
  s_mov_b32 m0, 93184
  s_add_u32 s70, s70, 9216
  s_waitcnt vmcnt(60)
  buffer_load_dwordx4 v43, s[44:47], s70 offen offset:0 nt lds
  s_add_u32 m0, m0, s98
  s_waitcnt vmcnt(60)
  buffer_load_dwordx4 v43, s[44:47], s70 offen offset:128 nt lds
  s_add_u32 m0, m0, s98
  s_waitcnt vmcnt(60)
  buffer_load_dwordx4 v43, s[44:47], s70 offen offset:256 nt lds
  s_add_u32 m0, m0, s98
  s_waitcnt vmcnt(60)
  buffer_load_dwordx4 v43, s[44:47], s70 offen offset:384 nt lds
  s_add_u32 m0, m0, s98
  s_waitcnt vmcnt(60)
  buffer_load_dwordx4 v43, s[44:47], s70 offen offset:512 nt lds
  s_add_u32 m0, m0, s98
  s_waitcnt vmcnt(60)
  buffer_load_dwordx4 v43, s[44:47], s70 offen offset:640 nt lds
  s_add_u32 m0, m0, s98
  s_waitcnt vmcnt(60)
  buffer_load_dwordx4 v43, s[44:47], s70 offen offset:768 nt lds
  s_add_u32 m0, m0, s98
  s_waitcnt vmcnt(60)
  buffer_load_dwordx4 v43, s[44:47], s70 offen offset:896 nt lds
  s_add_u32 m0, m0, s98
  s_waitcnt vmcnt(60)
  buffer_load_dwordx4 v43, s[44:47], s70 offen offset:1024 nt lds
  s_branch L_ffn
L_red:
  s_mov_b32 s60, s22
  s_mov_b32 s61, s23
  s_mov_b32 s62, 2304
  s_mov_b32 s63, 0x20000
  s_lshr_b32 s77, s101, 3
  s_lshr_b32 s76, s90, 2
  s_lshl_b32 s76, s76, 5
  s_and_b32 s70, s90, 1
  s_lshl_b32 s70, s70, 3
  s_add_u32 s76, s76, s70
  v_and_b32 v32, 3, v1
  v_lshl_add_u32 v33, v32, 1, s76
  v_lshrrev_b32 v34, 1, v2
  v_add_u32 v33, v33, v34
  v_and_b32 v34, 1, v2
  v_lshl_add_u32 v33, v34, 4, v33
  v_lshlrev_b32 v35, 1, v33
  v_lshrrev_b32 v36, 2, v3
  v_lshlrev_b32 v36, 8, v36
  v_lshl_add_u32 v36, v33, 1, v36
  s_bfe_u32 s76, s90, 0x10001
  s_mul_i32 s71, s76, 1152
  s_lshl_b32 s72, s77, 7
  s_add_u32 s71, s71, s72
  s_lshl_b32 s76, s76, 7
  s_and_b32 s70, s69, 0
  s_mul_i32 s70, s70, 18432
  s_add_u32 s70, s70, s76
  s_lshl_b32 s76, s77, 11
  s_add_u32 s70, s70, s76
  s_add_u32 s70, s70, 131072
  s_mov_b32 s76, s101
  s_mul_i32 s76, s76, 9216
  s_add_u32 s76, s76, 458752
  s_add_u32 s28, s76, 0
  s_add_u32 s29, s76, 4096
  s_add_u32 s30, s76, 8192
  s_mov_b64 s[38:39], -1
  s_mov_b64 s[40:41], -1
  s_mov_b64 s[42:43], -1
  s_mov_b64 s[44:45], -1
  s_mov_b64 s[46:47], -1
  s_mov_b64 s[48:49], -1
  s_mov_b64 s[50:51], -1
  s_mov_b64 s[80:81], -1
  s_mov_b64 s[82:83], -1
  s_mov_b32 s87, 0
  v_mov_b32 v141, 1
  s_waitcnt vmcnt(56)
  ds_write_b32 v5, v141 offset:372
  v_mov_b32 v143, 3
  s_waitcnt vmcnt(48)
  ds_write_b32 v5, v143 offset:372
  v_mov_b32 v141, 5
  s_waitcnt vmcnt(40)
  ds_write_b32 v5, v141 offset:372
  v_mov_b32 v143, 7
  s_waitcnt vmcnt(32)
  ds_write_b32 v5, v143 offset:372
  v_mov_b32 v141, 9
  s_waitcnt vmcnt(24)
  ds_write_b32 v5, v141 offset:372
  v_mov_b32 v142, 10
  s_waitcnt vmcnt(20)
  ds_write_b32 v5, v142 offset:372
  v_mov_b32 v143, 11
  s_waitcnt vmcnt(16)
  ds_write_b32 v5, v143 offset:372
  v_mov_b32 v141, 13
  s_waitcnt vmcnt(8)
  ds_write_b32 v5, v141 offset:372
  v_mov_b32 v143, 15
  s_waitcnt vmcnt(0)
  ds_write_b32 v5, v143 offset:372
  s_barrier
  buffer_load_ushort v41, v35, s[56:59], s71 offen
L_r1:
  s_sleep 8
  buffer_load_ushort v42, v36, s[52:55], s70 offen sc1
  buffer_load_ushort v43, v36, s[52:55], s70 offen offset:1024 sc1
  s_waitcnt vmcnt(0)
  v_max_u32 v40, v42, v43
  v_cvt_f32_f16 v42, v42
  v_cvt_f32_f16 v43, v43
  v_cmp_eq_u32 vcc, 0xffff, v40
  s_nop 3
  s_cbranch_vccz L_r1_ok
  s_add_u32 s87, s87, 1
  s_cmp_lt_u32 s87, 20000
  s_cbranch_scc1 L_r1
L_r1_ok:
  v_add_f32_dpp v42, v42, v42 row_ror:8 row_mask:0xf bank_mask:0xf
  v_add_f32_dpp v43, v43, v43 row_ror:8 row_mask:0xf bank_mask:0xf
  v_add_f32 v42, v42, v43
  s_nop 1
  v_add_f32_dpp v42, v42, v42 row_ror:4 row_mask:0xf bank_mask:0xf
  v_cvt_pk_bf16_f32 v42, v42, v42
  v_and_b32 v42, 0xffff0000, v42
  v_lshlrev_b32 v41, 16, v41
  v_add_f32 v42, v42, v41
  v_cvt_pk_bf16_f32 v42, v42, v42
  v_and_b32 v42, 0xffff0000, v42
  s_mov_b32 s87, 0
  buffer_load_dwordx4 v[44:47], v128, s[52:55], s28 offen offset:0 sc1
  buffer_load_dwordx4 v[48:51], v128, s[52:55], s28 offen offset:1024 sc1
  buffer_load_dwordx4 v[52:55], v128, s[52:55], s28 offen offset:2048 sc1
  buffer_load_dwordx4 v[56:59], v128, s[52:55], s28 offen offset:3072 sc1
  buffer_load_dwordx4 v[60:63], v128, s[52:55], s29 offen offset:0 sc1
  buffer_load_dwordx4 v[64:67], v128, s[52:55], s29 offen offset:1024 sc1
  buffer_load_dwordx4 v[68:71], v128, s[52:55], s29 offen offset:2048 sc1
  buffer_load_dwordx4 v[72:75], v128, s[52:55], s29 offen offset:3072 sc1
  buffer_load_dwordx4 v[76:79], v128, s[52:55], s30 offen offset:0 sc1
  s_mov_b64 exec, -1
  s_sleep 10
L_r2:
  s_or_b64 exec, s[38:39], 1
  buffer_load_dwordx4 v[44:47], v128, s[52:55], s28 offen offset:0 sc1
  s_or_b64 exec, s[40:41], 1
  buffer_load_dwordx4 v[48:51], v128, s[52:55], s28 offen offset:1024 sc1
  s_or_b64 exec, s[42:43], 1
  buffer_load_dwordx4 v[52:55], v128, s[52:55], s28 offen offset:2048 sc1
  s_or_b64 exec, s[44:45], 1
  buffer_load_dwordx4 v[56:59], v128, s[52:55], s28 offen offset:3072 sc1
  s_or_b64 exec, s[46:47], 1
  buffer_load_dwordx4 v[60:63], v128, s[52:55], s29 offen offset:0 sc1
  s_or_b64 exec, s[48:49], 1
  buffer_load_dwordx4 v[64:67], v128, s[52:55], s29 offen offset:1024 sc1
  s_or_b64 exec, s[50:51], 1
  buffer_load_dwordx4 v[68:71], v128, s[52:55], s29 offen offset:2048 sc1
  s_or_b64 exec, s[80:81], 1
  buffer_load_dwordx4 v[72:75], v128, s[52:55], s29 offen offset:3072 sc1
  s_or_b64 exec, s[82:83], 1
  buffer_load_dwordx4 v[76:79], v128, s[52:55], s30 offen offset:0 sc1
  s_mov_b64 exec, -1
  s_waitcnt vmcnt(17)
  v_xor_b32 v80, s75, v44
  v_xor_b32 v81, s75, v45
  v_xor_b32 v82, s75, v46
  v_xor_b32 v83, s75, v47
  v_or3_b32 v116, v80, v81, v82
  v_or_b32 v116, v116, v83
  s_waitcnt vmcnt(16)
  v_xor_b32 v84, s75, v48
  v_xor_b32 v85, s75, v49
  v_xor_b32 v86, s75, v50
  v_xor_b32 v87, s75, v51
  v_or3_b32 v117, v84, v85, v86
  v_pk_add_f32 v[24:25], v[80:81], v[84:85]
  v_pk_add_f32 v[26:27], v[82:83], v[86:87]
  v_or_b32 v117, v117, v87
  v_or_b32 v40, v116, v117
  s_waitcnt vmcnt(15)
  v_xor_b32 v88, s75, v52
  v_xor_b32 v89, s75, v53
  v_xor_b32 v90, s75, v54
  v_xor_b32 v91, s75, v55
  v_or3_b32 v118, v88, v89, v90
  v_pk_add_f32 v[24:25], v[24:25], v[88:89]
  v_pk_add_f32 v[26:27], v[26:27], v[90:91]
  v_or_b32 v118, v118, v91
  v_or_b32 v40, v40, v118
  s_waitcnt vmcnt(14)
  v_xor_b32 v92, s75, v56
  v_xor_b32 v93, s75, v57
  v_xor_b32 v94, s75, v58
  v_xor_b32 v95, s75, v59
  v_or3_b32 v119, v92, v93, v94
  v_pk_add_f32 v[24:25], v[24:25], v[92:93]
  v_pk_add_f32 v[26:27], v[26:27], v[94:95]
  v_or_b32 v119, v119, v95
  v_or_b32 v40, v40, v119
  s_waitcnt vmcnt(13)
  v_xor_b32 v96, s75, v60
  v_xor_b32 v97, s75, v61
  v_xor_b32 v98, s75, v62
  v_xor_b32 v99, s75, v63
  v_or3_b32 v120, v96, v97, v98
  v_pk_add_f32 v[24:25], v[24:25], v[96:97]
  v_pk_add_f32 v[26:27], v[26:27], v[98:99]
  v_or_b32 v120, v120, v99
  v_or_b32 v40, v40, v120
  s_waitcnt vmcnt(12)
  v_xor_b32 v100, s75, v64
  v_xor_b32 v101, s75, v65
  v_xor_b32 v102, s75, v66
  v_xor_b32 v103, s75, v67
  v_or3_b32 v121, v100, v101, v102
  v_pk_add_f32 v[24:25], v[24:25], v[100:101]
  v_pk_add_f32 v[26:27], v[26:27], v[102:103]
  v_or_b32 v121, v121, v103
  v_or_b32 v40, v40, v121
  s_waitcnt vmcnt(11)
  v_xor_b32 v104, s75, v68
  v_xor_b32 v105, s75, v69
  v_xor_b32 v106, s75, v70
  v_xor_b32 v107, s75, v71
  v_or3_b32 v122, v104, v105, v106
  v_pk_add_f32 v[24:25], v[24:25], v[104:105]
  v_pk_add_f32 v[26:27], v[26:27], v[106:107]
  v_or_b32 v122, v122, v107
  v_or_b32 v40, v40, v122
  s_waitcnt vmcnt(10)
  v_xor_b32 v108, s75, v72
  v_xor_b32 v109, s75, v73
  v_xor_b32 v110, s75, v74
  v_xor_b32 v111, s75, v75
  v_or3_b32 v123, v108, v109, v110
  v_pk_add_f32 v[24:25], v[24:25], v[108:109]
  v_pk_add_f32 v[26:27], v[26:27], v[110:111]
  v_or_b32 v123, v123, v111
  v_or_b32 v40, v40, v123
  s_waitcnt vmcnt(9)
  v_xor_b32 v112, s75, v76
  v_xor_b32 v113, s75, v77
  v_xor_b32 v114, s75, v78
  v_xor_b32 v115, s75, v79
  v_or3_b32 v124, v112, v113, v114
  v_pk_add_f32 v[24:25], v[24:25], v[112:113]
  v_pk_add_f32 v[26:27], v[26:27], v[114:115]
  v_or_b32 v124, v124, v115
  v_or_b32 v40, v40, v124
  v_cmp_ne_u32_sdwa vcc, v40, v5 src0_sel:BYTE_0 src1_sel:DWORD
  v_permlane16_swap_b32 v24, v25
  v_permlane16_swap_b32 v26, v27
  v_add_f32 v24, v24, v25
  v_add_f32 v26, v26, v27
  s_nop 1
  v_permlane32_swap_b32 v24, v26
  v_add_f32 v24, v24, v26
  s_nop 1
  v_add_f32_dpp v24, v24, v24 row_ror:4 row_mask:0xf bank_mask:0xf
  s_nop 1
  v_add_f32_dpp v24, v24, v24 row_ror:8 row_mask:0xf bank_mask:0xf
  v_cvt_pk_bf16_f32 v24, v24, v24
  v_and_b32 v24, 0xffff0000, v24
  v_add_f32 v24, v24, v42
  v_cvt_pk_bf16_f32 v24, v24, v24
  s_nop 0
  s_cbranch_vccz L_r2_ok
  v_cmp_ne_u32_sdwa s[38:39], v116, v5 src0_sel:BYTE_0 src1_sel:DWORD
  v_cmp_ne_u32_sdwa s[40:41], v117, v5 src0_sel:BYTE_0 src1_sel:DWORD
  v_cmp_ne_u32_sdwa s[42:43], v118, v5 src0_sel:BYTE_0 src1_sel:DWORD
  v_cmp_ne_u32_sdwa s[44:45], v119, v5 src0_sel:BYTE_0 src1_sel:DWORD
  v_cmp_ne_u32_sdwa s[46:47], v120, v5 src0_sel:BYTE_0 src1_sel:DWORD
  v_cmp_ne_u32_sdwa s[48:49], v121, v5 src0_sel:BYTE_0 src1_sel:DWORD
  v_cmp_ne_u32_sdwa s[50:51], v122, v5 src0_sel:BYTE_0 src1_sel:DWORD
  v_cmp_ne_u32_sdwa s[80:81], v123, v5 src0_sel:BYTE_0 src1_sel:DWORD
  v_cmp_ne_u32_sdwa s[82:83], v124, v5 src0_sel:BYTE_0 src1_sel:DWORD
  s_add_u32 s87, s87, 1
  s_cmp_lt_u32 s87, 60000
  s_nop 1
  s_cbranch_scc1 L_r2
L_r2_ok:
  s_mov_b32 exec_lo, 0x000f000f
  s_mov_b32 exec_hi, 0x000f000f
  buffer_store_short v24, v35, s[60:63], s71 offen
  s_mov_b64 exec, -1
L_fin:
  s_endpgm
L_end:
  s_endpgm
.section .rodata,"a"
.p2align 6
.amdhsa_kernel sequential_preLN__mha_block_cached__glu_gated_geglu__decode_kernel
  .amdhsa_next_free_vgpr 168
  .amdhsa_next_free_sgpr 102
  .amdhsa_accum_offset 168
  .amdhsa_group_segment_fixed_size 0
  .amdhsa_kernarg_size 96
  .amdhsa_user_sgpr_count 2
  .amdhsa_user_sgpr_kernarg_segment_ptr 1
  .amdhsa_system_sgpr_workgroup_id_x 1
.end_amdhsa_kernel
```
